```python
import torch

def _softmax(x, axis=-1):
    return torch.softmax(x, dim=axis)
def _gelu(x):
    return torch.nn.functional.gelu(x, approximate="tanh")
def _silu(x):
    return torch.nn.functional.silu(x)
def _sigmoid(x):
    return torch.sigmoid(x)
def _layernorm(x, axis=-1, eps=1e-5):
    m = x.mean(dim=axis, keepdim=True)
    v = x.var(dim=axis, keepdim=True, unbiased=False)
    return (x - m) / torch.sqrt(v + eps)
def _scatter_add(tgt, idx, src, axis=0):
    return tgt.clone().index_add_(axis, idx, src)
def _segment_sum(src, seg, n):
    out = torch.zeros((n,) + src.shape[1:], dtype=src.dtype)
    return out.index_add_(0, seg, src)
def _pad(x, pw):
    flat = tuple(v for pair in reversed(pw) for v in pair)
    return torch.nn.functional.pad(x, flat)

kernel_name = 'parallel_sum__gqa_block_cached__glu_gated_swiglu__decode'

def setup_inputs():

    _w = (lambda a: (lambda t: t.to(torch.bfloat16) if t.is_floating_point() else t)(torch.as_tensor(a)))
    def _A_setup():
        B, Sq, D = 1, 1, 512
        Hq, Hkv, Sk, Dh = 32, 8, 65536, 128
        assert Hq % Hkv == 0, (Hq, Hkv)
        return {
            "x": _w((lambda *s: torch.randn(*s, dtype=torch.bfloat16) * 0.05)(B, Sq, D)),
            "k_cache": _w((lambda *s: torch.randn(*s, dtype=torch.bfloat16) * 3.2)(B, Hkv, Sk, Dh)),
            "v_cache": _w((lambda *s: torch.randn(*s, dtype=torch.bfloat16) * 1.6)(B, Hkv, Sk, Dh)),
            "wq": _w((lambda *s: torch.randn(*s, dtype=torch.bfloat16) * 3.2)(D, Hq * Dh) * (D ** -0.5)),
            "wo": _w((lambda *s: torch.randn(*s, dtype=torch.bfloat16) * 1.6)(Hq * Dh, D) * ((Hq * Dh) ** -0.5)),
        }
    _A_in = _A_setup()

    def _B_setup():
        B, S, D, F = 1, 1, 512, 1792
        return {
            "x": _w((lambda *s: torch.randn(*s, dtype=torch.bfloat16) * 0.05)(B, S, D)),
            "w1": _w((lambda *s: torch.randn(*s, dtype=torch.bfloat16) * 1.6)(D, F) * (2.0 / D) ** 0.5),
            "w3": _w((lambda *s: torch.randn(*s, dtype=torch.bfloat16) * 1.6)(D, F) * (2.0 / D) ** 0.5),
            "w2": _w((lambda *s: torch.randn(*s, dtype=torch.bfloat16) * 1.6)(F, D) * (2.0 / F) ** 0.5),
        }
    _B_in = _B_setup()

    return {
        "A_x": _A_in["x"],
        "A_k_cache": _A_in["k_cache"],
        "A_v_cache": _A_in["v_cache"],
        "A_wq": _A_in["wq"],
        "A_wo": _A_in["wo"],
        "B_x": _B_in["x"],
        "B_w1": _B_in["w1"],
        "B_w3": _B_in["w3"],
        "B_w2": _B_in["w2"],
    }

def reference(A_x, A_k_cache, A_v_cache, A_wq, A_wo, B_x, B_w1, B_w3, B_w2):
    def _A_ref(x, k_cache, v_cache, wq, wo):
        B, Sq, D = x.shape
        Hq, Dh = 32, 128
        Hkv = k_cache.shape[1]
        rep = Hq // Hkv
        q = (lambda x, *d: x.permute(*d))((x @ wq).reshape(B, Sq, Hq, Dh), 0, 2, 1, 3)
        k = (lambda x, n, axis: torch.repeat_interleave(x, n, dim=axis))(k_cache, rep, axis=1)
        v = (lambda x, n, axis: torch.repeat_interleave(x, n, dim=axis))(v_cache, rep, axis=1)
        scores = torch.einsum("bhqd,bhkd->bhqk", q, k) * (Dh ** -0.5)
        p = _softmax(scores, axis=-1)
        o = torch.einsum("bhqk,bhkd->bhqd", p, v)
        return (lambda x, *d: x.permute(*d))(o, 0, 2, 1, 3).reshape(B, Sq, Hq * Dh) @ wo

    def _B_ref(x, w1, w3, w2):
        gate = torch.einsum("bsd,df->bsf", x, w1)
        up = torch.einsum("bsd,df->bsf", x, w3)
        h = _silu(gate) * up
        out = torch.einsum("bsf,fd->bsd", h, w2)
        return out

    x = A_x
    xn = _layernorm(x, axis=-1)
    return x + _A_ref(xn, A_k_cache, A_v_cache, A_wq, A_wo) + _B_ref(xn, B_w1, B_w3, B_w2)
```

```asm
; @launch grid=(256,1,1) block=(512,1,1) lds=26112
.amdgcn_target "amdgcn-amd-amdhsa--gfx950"
.text
.globl parallel_sum__gqa_block_cached__glu_gated_swiglu__decode_kernel
.p2align 8
.type parallel_sum__gqa_block_cached__glu_gated_swiglu__decode_kernel,@function
parallel_sum__gqa_block_cached__glu_gated_swiglu__decode_kernel:
    s_cmp_ge_u32 s2, 256
    s_nop 0
    s_cbranch_scc1 A_end
    s_load_dwordx4 s[4:7], s[0:1], 8
    s_load_dwordx2 s[8:9], s[0:1], 0
    s_load_dwordx4 s[76:79], s[0:1], 24
    s_load_dwordx4 s[36:39], s[0:1], 48
    s_load_dwordx4 s[80:83], s[0:1], 64
    s_load_dwordx2 s[42:43], s[0:1], 88
    v_and_b32 v1, 63, v0
    v_lshrrev_b32 v2, 6, v0
    s_nop 0
    v_readfirstlane_b32 s3, v2
    s_and_b32 s14, s2, 7
    s_lshr_b32 s15, s2, 3
    s_getpc_b64 s[98:99]
A_pc:
    s_add_u32 s98, s98, A_switch-A_pc
    s_addc_u32 s99, s99, 0
    s_waitcnt lgkmcnt(0)
    s_add_u32 s40, s42, 10485760
    s_addc_u32 s41, s43, 0
    s_load_dword s75, s[40:41], 0
    s_mov_b32 s16, s4
    s_and_b32 s17, s5, 0xffff
    s_mov_b32 s18, 0x8000000
    s_mov_b32 s19, 0x20000
    s_mov_b32 s20, s6
    s_and_b32 s21, s7, 0xffff
    s_mov_b32 s22, 0x8000000
    s_mov_b32 s23, 0x20000
    s_mov_b32 s24, s42
    s_and_b32 s25, s43, 0xffff
    s_mov_b32 s26, 0x20000000
    s_mov_b32 s27, 0x20000
    s_mov_b64 s[96:97], s[78:79]
    s_mov_b32 s44, s8
    s_and_b32 s45, s9, 0xffff
    s_mov_b32 s46, 0x400
    s_mov_b32 s47, 0x20000
    s_mov_b32 s48, s76
    s_and_b32 s49, s77, 0xffff
    s_mov_b32 s50, 0x400000
    s_mov_b32 s51, 0x20000
    s_mov_b32 s52, s36
    s_and_b32 s53, s37, 0xffff
    s_mov_b32 s54, 0x1c0000
    s_mov_b32 s55, 0x20000
    s_mov_b32 s56, s38
    s_and_b32 s57, s39, 0xffff
    s_mov_b32 s58, 0x1c0000
    s_mov_b32 s59, 0x20000
    s_mul_i32 s64, s14, 28
    s_add_u32 s64, s64, s15
    v_and_b32 v2, 15, v1
    v_lshrrev_b32 v3, 4, v1
    v_and_b32 v4, 3, v2
    v_lshlrev_b32 v4, 2, v4
    v_lshrrev_b32 v5, 2, v2
    v_add_u32 v4, v4, v5
    v_lshlrev_b32 v4, 8, v4
    v_lshlrev_b32 v5, 4, v3
    v_add_u32 v4, v4, v5
    v_add_u32 v5, 4096, v4
    v_lshlrev_b32 v6, 4, v1
    v_add_u32 v7, 4096, v6
    s_mov_b32 s62, 0
    s_mul_i32 s28, s15, 63
    s_mov_b32 s93, 63
    s_cmp_lt_u32 s15, 14
    s_nop 0
    s_cbranch_scc1 A_bal
    s_sub_u32 s30, s15, 14
    s_mul_i32 s28, s30, 64
    s_add_u32 s28, s28, 882
    s_mov_b32 s93, 64
    s_cmp_lt_u32 s15, 28
    s_nop 0
    s_cbranch_scc1 A_bal
    s_sub_u32 s30, s15, 28
    s_mul_i32 s28, s30, 67
    s_min_u32 s31, s30, 2
    s_add_u32 s28, s28, s31
    s_add_u32 s28, s28, 1778
    s_mov_b32 s93, 67
    s_cmp_lt_u32 s30, 2
    s_addc_u32 s93, s93, 0
    s_nop 0
A_bal:
    s_mov_b32 s32, 0x05040100
    s_mov_b32 s33, 0x07060302
    s_mov_b32 s34, 0x3fb8aa3b
    s_mov_b32 s35, 0x3db504f3
    s_sub_u32 s73, s3, 1
    s_lshl_b32 s77, s73, 14
    s_add_u32 s77, s77, 25088
    s_mov_b32 s60, 0
    s_add_u32 s66, s73, s28
    s_lshl_b32 s66, s66, 13
    s_lshl_b32 s63, s14, 24
    s_add_u32 s66, s66, s63
    s_add_u32 s73, s3, 6
    s_mov_b32 s61, 0
    s_add_u32 s67, s73, s28
    s_lshl_b32 s67, s67, 13
    s_lshl_b32 s63, s14, 24
    s_add_u32 s67, s67, s63
    s_add_u32 s73, s3, s93
    s_sub_u32 s73, s73, 1
    s_mov_b32 s74, 0
    s_add_u32 s76, s73, s28
    s_lshl_b32 s76, s76, 13
    s_lshl_b32 s63, s14, 24
    s_add_u32 s76, s76, s63
    s_cmp_lt_u32 s3, 4
    s_nop 0
    s_cbranch_scc1 A_headw
    s_barrier
    buffer_load_dwordx4 v[64:67], v4, s[16:19], s66 offen offset:0 nt
    buffer_load_dwordx4 v[68:71], v4, s[16:19], s66 offen offset:64 nt
    buffer_load_dwordx4 v[72:75], v4, s[16:19], s66 offen offset:128 nt
    buffer_load_dwordx4 v[76:79], v4, s[16:19], s66 offen offset:192 nt
    buffer_load_dwordx4 v[80:83], v5, s[16:19], s66 offen offset:0 nt
    buffer_load_dwordx4 v[84:87], v5, s[16:19], s66 offen offset:64 nt
    buffer_load_dwordx4 v[88:91], v5, s[16:19], s66 offen offset:128 nt
    buffer_load_dwordx4 v[92:95], v5, s[16:19], s66 offen offset:192 nt
    buffer_load_dwordx4 v[128:131], v6, s[20:23], s66 offen offset:0 nt
    buffer_load_dwordx4 v[132:135], v6, s[20:23], s66 offen offset:1024 nt
    buffer_load_dwordx4 v[136:139], v6, s[20:23], s66 offen offset:2048 nt
    buffer_load_dwordx4 v[140:143], v6, s[20:23], s66 offen offset:3072 nt
    buffer_load_dwordx4 v[144:147], v7, s[20:23], s66 offen offset:0 nt
    buffer_load_dwordx4 v[148:151], v7, s[20:23], s66 offen offset:1024 nt
    buffer_load_dwordx4 v[152:155], v7, s[20:23], s66 offen offset:2048 nt
    buffer_load_dwordx4 v[156:159], v7, s[20:23], s66 offen offset:3072 nt
    buffer_load_dwordx4 v[96:99], v4, s[16:19], s67 offen offset:0 nt
    buffer_load_dwordx4 v[100:103], v4, s[16:19], s67 offen offset:64 nt
    buffer_load_dwordx4 v[104:107], v4, s[16:19], s67 offen offset:128 nt
    buffer_load_dwordx4 v[108:111], v4, s[16:19], s67 offen offset:192 nt
    buffer_load_dwordx4 v[112:115], v5, s[16:19], s67 offen offset:0 nt
    buffer_load_dwordx4 v[116:119], v5, s[16:19], s67 offen offset:64 nt
    buffer_load_dwordx4 v[120:123], v5, s[16:19], s67 offen offset:128 nt
    buffer_load_dwordx4 v[124:127], v5, s[16:19], s67 offen offset:192 nt
    s_waitcnt vmcnt(16)
    buffer_load_dwordx4 v[160:163], v6, s[20:23], s67 offen offset:0 nt
    buffer_load_dwordx4 v[164:167], v6, s[20:23], s67 offen offset:1024 nt
    buffer_load_dwordx4 v[168:171], v6, s[20:23], s67 offen offset:2048 nt
    buffer_load_dwordx4 v[172:175], v6, s[20:23], s67 offen offset:3072 nt
    buffer_load_dwordx4 v[176:179], v7, s[20:23], s67 offen offset:0 nt
    buffer_load_dwordx4 v[180:183], v7, s[20:23], s67 offen offset:1024 nt
    buffer_load_dwordx4 v[184:187], v7, s[20:23], s67 offen offset:2048 nt
    buffer_load_dwordx4 v[188:191], v7, s[20:23], s67 offen offset:3072 nt
    s_cmp_gt_u32 s3, 0
    s_nop 0
    s_cbranch_scc1 A_nol1
    s_waitcnt vmcnt(16)
    s_add_u32 s30, s77, 0
    s_mov_b32 m0, s30
    s_nop 0
    buffer_load_dwordx4 v6, s[16:19], s76 offen offset:0 nt lds
    buffer_load_dwordx4 v6, s[16:19], s76 offen offset:1024 nt lds
    buffer_load_dwordx4 v6, s[16:19], s76 offen offset:2048 nt lds
    buffer_load_dwordx4 v6, s[16:19], s76 offen offset:3072 nt lds
    s_add_u32 s30, s77, 4096
    s_mov_b32 m0, s30
    s_nop 0
    buffer_load_dwordx4 v7, s[16:19], s76 offen offset:0 nt lds
    buffer_load_dwordx4 v7, s[16:19], s76 offen offset:1024 nt lds
    buffer_load_dwordx4 v7, s[16:19], s76 offen offset:2048 nt lds
    buffer_load_dwordx4 v7, s[16:19], s76 offen offset:3072 nt lds
    s_waitcnt vmcnt(16)
    s_add_u32 s30, s77, 8192
    s_mov_b32 m0, s30
    s_nop 0
    buffer_load_dwordx4 v6, s[20:23], s76 offen offset:0 nt lds
    buffer_load_dwordx4 v6, s[20:23], s76 offen offset:1024 nt lds
    buffer_load_dwordx4 v6, s[20:23], s76 offen offset:2048 nt lds
    buffer_load_dwordx4 v6, s[20:23], s76 offen offset:3072 nt lds
    s_add_u32 s30, s77, 12288
    s_mov_b32 m0, s30
    s_nop 0
    buffer_load_dwordx4 v7, s[20:23], s76 offen offset:0 nt lds
    buffer_load_dwordx4 v7, s[20:23], s76 offen offset:1024 nt lds
    buffer_load_dwordx4 v7, s[20:23], s76 offen offset:2048 nt lds
    buffer_load_dwordx4 v7, s[20:23], s76 offen offset:3072 nt lds
A_nol1:
    s_waitcnt lgkmcnt(0)
    s_add_u32 s75, s75, 1
    s_nop 0
    s_branch A_wait_q
A_headw:
    v_lshlrev_b32 v8, 4, v1
    buffer_load_dwordx4 v[48:51], v8, s[44:47], 0 offen
    v_lshlrev_b32 v9, 1, v0
    buffer_load_ushort v52, v9, s[44:47], 0 offen
    buffer_load_ushort v53, v9, s[44:47], 0 offen offset:512
    v_lshlrev_b32 v8, 13, v0
    s_lshl_b32 s30, s14, 10
    s_lshl_b32 s31, s15, 5
    s_add_u32 s30, s30, s31
    s_add_u32 s29, s30, 0x200000
    buffer_load_dwordx4 v[16:19], v8, s[48:51], s30 offen
    buffer_load_dwordx4 v[20:23], v8, s[48:51], s30 offen offset:16
    buffer_load_dwordx4 v[24:27], v8, s[48:51], s29 offen
    buffer_load_dwordx4 v[28:31], v8, s[48:51], s29 offen offset:16
    s_cmp_lg_u32 s3, 0
    s_nop 0
    s_cbranch_scc1 A_noinit
    v_mov_b32 v8, 14
    v_mov_b32 v9, 0
    v_mov_b32 v10, 1024
    ds_write_b64 v10, v[8:9]
    s_waitcnt lgkmcnt(0)
    s_nop 2
A_noinit:
    s_barrier
    s_waitcnt vmcnt(4)
    v_lshlrev_b32 v224, 16, v48
    v_and_b32 v225, 0xffff0000, v48
    v_lshlrev_b32 v226, 16, v49
    v_and_b32 v227, 0xffff0000, v49
    v_lshlrev_b32 v228, 16, v50
    v_and_b32 v229, 0xffff0000, v50
    v_lshlrev_b32 v230, 16, v51
    v_and_b32 v231, 0xffff0000, v51
    v_add_f32 v56, v224, v225
    v_add_f32 v56, v56, v226
    v_add_f32 v56, v56, v227
    v_add_f32 v56, v56, v228
    v_add_f32 v56, v56, v229
    v_add_f32 v56, v56, v230
    v_add_f32 v56, v56, v231
    s_nop 1
    v_add_f32_dpp v56, v56, v56 row_ror:1 row_mask:0xf bank_mask:0xf
    s_nop 1
    v_add_f32_dpp v56, v56, v56 row_ror:2 row_mask:0xf bank_mask:0xf
    s_nop 1
    v_add_f32_dpp v56, v56, v56 row_ror:4 row_mask:0xf bank_mask:0xf
    s_nop 1
    v_add_f32_dpp v56, v56, v56 row_ror:8 row_mask:0xf bank_mask:0xf
    v_mov_b32 v57, v56
    s_nop 1
    v_permlane16_swap_b32 v56, v57
    v_add_f32 v56, v56, v57
    v_mov_b32 v57, v56
    s_nop 1
    v_permlane32_swap_b32 v56, v57
    v_add_f32 v56, v56, v57
    v_mul_f32 v59, 0x3b000000, v56
    v_sub_f32 v61, v224, v59
    v_mul_f32 v60, v61, v61
    v_sub_f32 v61, v225, v59
    v_fmac_f32 v60, v61, v61
    v_sub_f32 v61, v226, v59
    v_fmac_f32 v60, v61, v61
    v_sub_f32 v61, v227, v59
    v_fmac_f32 v60, v61, v61
    v_sub_f32 v61, v228, v59
    v_fmac_f32 v60, v61, v61
    v_sub_f32 v61, v229, v59
    v_fmac_f32 v60, v61, v61
    v_sub_f32 v61, v230, v59
    v_fmac_f32 v60, v61, v61
    v_sub_f32 v61, v231, v59
    v_fmac_f32 v60, v61, v61
    s_nop 1
    v_add_f32_dpp v60, v60, v60 row_ror:1 row_mask:0xf bank_mask:0xf
    s_nop 1
    v_add_f32_dpp v60, v60, v60 row_ror:2 row_mask:0xf bank_mask:0xf
    s_nop 1
    v_add_f32_dpp v60, v60, v60 row_ror:4 row_mask:0xf bank_mask:0xf
    s_nop 1
    v_add_f32_dpp v60, v60, v60 row_ror:8 row_mask:0xf bank_mask:0xf
    v_mov_b32 v57, v60
    s_nop 1
    v_permlane16_swap_b32 v60, v57
    v_add_f32 v60, v60, v57
    v_mov_b32 v57, v60
    s_nop 1
    v_permlane32_swap_b32 v60, v57
    v_add_f32 v60, v60, v57
    v_mul_f32 v60, 0x3b000000, v60
    v_cvt_pk_bf16_f32 v60, v60, v60
    v_lshlrev_b32 v60, 16, v60
    v_cvt_pk_bf16_f32 v59, v59, v59
    v_lshlrev_b32 v59, 16, v59
    v_add_f32 v60, 0x3727c5ac, v60
    v_cvt_pk_bf16_f32 v60, v60, v60
    v_lshlrev_b32 v60, 16, v60
    v_sqrt_f32 v60, v60
    s_nop 0
    v_cvt_pk_bf16_f32 v60, v60, v60
    v_lshlrev_b32 v60, 16, v60
    v_rcp_f32 v57, v60
    v_lshlrev_b32 v62, 16, v52
    v_sub_f32 v62, v62, v59
    v_cvt_pk_bf16_f32 v62, v62, v62
    v_lshlrev_b32 v62, 16, v62
    v_mul_f32 v61, v62, v57
    v_fma_f32 v58, -v61, v60, v62
    v_fma_f32 v62, v58, v57, v61
    v_cvt_pk_bf16_f32 v62, v62, v62
    v_lshlrev_b32 v62, 16, v62
    v_lshlrev_b32 v63, 16, v53
    v_sub_f32 v63, v63, v59
    v_cvt_pk_bf16_f32 v63, v63, v63
    v_lshlrev_b32 v63, 16, v63
    v_mul_f32 v61, v63, v57
    v_fma_f32 v58, -v61, v60, v63
    v_fma_f32 v63, v58, v57, v61
    v_cvt_pk_bf16_f32 v63, v63, v63
    v_lshlrev_b32 v63, 16, v63
    s_waitcnt vmcnt(0)
    v_lshlrev_b32 v192, 16, v16
    v_and_b32 v193, 0xffff0000, v16
    v_lshlrev_b32 v208, 16, v24
    v_and_b32 v209, 0xffff0000, v24
    v_mul_f32 v192, v192, v62
    v_mul_f32 v193, v193, v62
    v_fmac_f32 v192, v208, v63
    v_fmac_f32 v193, v209, v63
    v_lshlrev_b32 v194, 16, v17
    v_and_b32 v195, 0xffff0000, v17
    v_lshlrev_b32 v208, 16, v25
    v_and_b32 v209, 0xffff0000, v25
    v_mul_f32 v194, v194, v62
    v_mul_f32 v195, v195, v62
    v_fmac_f32 v194, v208, v63
    v_fmac_f32 v195, v209, v63
    v_lshlrev_b32 v196, 16, v18
    v_and_b32 v197, 0xffff0000, v18
    v_lshlrev_b32 v208, 16, v26
    v_and_b32 v209, 0xffff0000, v26
    v_mul_f32 v196, v196, v62
    v_mul_f32 v197, v197, v62
    v_fmac_f32 v196, v208, v63
    v_fmac_f32 v197, v209, v63
    v_lshlrev_b32 v198, 16, v19
    v_and_b32 v199, 0xffff0000, v19
    v_lshlrev_b32 v208, 16, v27
    v_and_b32 v209, 0xffff0000, v27
    v_mul_f32 v198, v198, v62
    v_mul_f32 v199, v199, v62
    v_fmac_f32 v198, v208, v63
    v_fmac_f32 v199, v209, v63
    v_lshlrev_b32 v200, 16, v20
    v_and_b32 v201, 0xffff0000, v20
    v_lshlrev_b32 v208, 16, v28
    v_and_b32 v209, 0xffff0000, v28
    v_mul_f32 v200, v200, v62
    v_mul_f32 v201, v201, v62
    v_fmac_f32 v200, v208, v63
    v_fmac_f32 v201, v209, v63
    v_lshlrev_b32 v202, 16, v21
    v_and_b32 v203, 0xffff0000, v21
    v_lshlrev_b32 v208, 16, v29
    v_and_b32 v209, 0xffff0000, v29
    v_mul_f32 v202, v202, v62
    v_mul_f32 v203, v203, v62
    v_fmac_f32 v202, v208, v63
    v_fmac_f32 v203, v209, v63
    v_lshlrev_b32 v204, 16, v22
    v_and_b32 v205, 0xffff0000, v22
    v_lshlrev_b32 v208, 16, v30
    v_and_b32 v209, 0xffff0000, v30
    v_mul_f32 v204, v204, v62
    v_mul_f32 v205, v205, v62
    v_fmac_f32 v204, v208, v63
    v_fmac_f32 v205, v209, v63
    v_lshlrev_b32 v206, 16, v23
    v_and_b32 v207, 0xffff0000, v23
    v_lshlrev_b32 v208, 16, v31
    v_and_b32 v209, 0xffff0000, v31
    v_mul_f32 v206, v206, v62
    v_mul_f32 v207, v207, v62
    v_fmac_f32 v206, v208, v63
    v_fmac_f32 v207, v209, v63
    v_permlane32_swap_b32 v192, v200
    v_add_f32 v192, v192, v200
    v_permlane32_swap_b32 v193, v201
    v_add_f32 v193, v193, v201
    v_permlane32_swap_b32 v194, v202
    v_add_f32 v194, v194, v202
    v_permlane32_swap_b32 v195, v203
    v_add_f32 v195, v195, v203
    v_permlane32_swap_b32 v196, v204
    v_add_f32 v196, v196, v204
    v_permlane32_swap_b32 v197, v205
    v_add_f32 v197, v197, v205
    v_permlane32_swap_b32 v198, v206
    v_add_f32 v198, v198, v206
    v_permlane32_swap_b32 v199, v207
    v_add_f32 v199, v199, v207
    v_permlane16_swap_b32 v192, v196
    v_add_f32 v192, v192, v196
    v_permlane16_swap_b32 v193, v197
    v_add_f32 v193, v193, v197
    v_permlane16_swap_b32 v194, v198
    v_add_f32 v194, v194, v198
    v_permlane16_swap_b32 v195, v199
    v_add_f32 v195, v195, v199
    v_add_f32_dpp v192, v192, v192 row_ror:1 row_mask:0xf bank_mask:0xf
    v_add_f32_dpp v193, v193, v193 row_ror:1 row_mask:0xf bank_mask:0xf
    v_add_f32_dpp v194, v194, v194 row_ror:1 row_mask:0xf bank_mask:0xf
    v_add_f32_dpp v195, v195, v195 row_ror:1 row_mask:0xf bank_mask:0xf
    v_add_f32_dpp v192, v192, v192 row_ror:2 row_mask:0xf bank_mask:0xf
    v_add_f32_dpp v193, v193, v193 row_ror:2 row_mask:0xf bank_mask:0xf
    v_add_f32_dpp v194, v194, v194 row_ror:2 row_mask:0xf bank_mask:0xf
    v_add_f32_dpp v195, v195, v195 row_ror:2 row_mask:0xf bank_mask:0xf
    v_add_f32_dpp v192, v192, v192 row_ror:4 row_mask:0xf bank_mask:0xf
    v_add_f32_dpp v193, v193, v193 row_ror:4 row_mask:0xf bank_mask:0xf
    v_add_f32_dpp v194, v194, v194 row_ror:4 row_mask:0xf bank_mask:0xf
    v_add_f32_dpp v195, v195, v195 row_ror:4 row_mask:0xf bank_mask:0xf
    v_add_f32_dpp v192, v192, v192 row_ror:8 row_mask:0xf bank_mask:0xf
    v_add_f32_dpp v193, v193, v193 row_ror:8 row_mask:0xf bank_mask:0xf
    v_add_f32_dpp v194, v194, v194 row_ror:8 row_mask:0xf bank_mask:0xf
    v_add_f32_dpp v195, v195, v195 row_ror:8 row_mask:0xf bank_mask:0xf
    s_lshl_b32 s30, s3, 6
    v_lshlrev_b32 v10, 4, v3
    v_add_u32 v10, s30, v10
    v_cmp_eq_u32 vcc, 0, v2
    s_nop 0
    s_and_saveexec_b64 s[68:69], vcc
    ds_write_b128 v10, v[192:195] offset:0
    s_mov_b64 exec, s[68:69]
    s_waitcnt lgkmcnt(0)
    s_add_u32 s75, s75, 1
    s_cmp_eq_u32 s3, 0
    s_nop 0
    s_cbranch_scc1 A_w0
    v_mov_b32 v10, 1028
    v_mov_b32 v11, 1
    s_mov_b64 exec, 1
    ds_add_u32 v10, v11
    s_mov_b64 exec, -1
    s_lshl_b32 s31, s64, 4
    s_cmp_ge_u32 s2, 224
    s_cselect_b32 s31, 0x7f000000, s31
    s_add_u32 s29, s31, 917504
    s_mov_b32 s65, 3584
    v_mul_lo_u32 v9, v0, s65
    buffer_load_dwordx4 v[32:35], v9, s[52:55], s31 offen
    buffer_load_dwordx4 v[36:39], v9, s[56:59], s31 offen
    buffer_load_dwordx4 v[40:43], v9, s[52:55], s29 offen
    buffer_load_dwordx4 v[44:47], v9, s[56:59], s29 offen
    s_waitcnt vmcnt(0)
    v_lshlrev_b32 v192, 16, v32
    v_and_b32 v193, 0xffff0000, v32
    v_lshlrev_b32 v208, 16, v40
    v_and_b32 v209, 0xffff0000, v40
    v_mul_f32 v192, v192, v62
    v_mul_f32 v193, v193, v62
    v_fmac_f32 v192, v208, v63
    v_fmac_f32 v193, v209, v63
    v_lshlrev_b32 v194, 16, v33
    v_and_b32 v195, 0xffff0000, v33
    v_lshlrev_b32 v208, 16, v41
    v_and_b32 v209, 0xffff0000, v41
    v_mul_f32 v194, v194, v62
    v_mul_f32 v195, v195, v62
    v_fmac_f32 v194, v208, v63
    v_fmac_f32 v195, v209, v63
    v_lshlrev_b32 v196, 16, v34
    v_and_b32 v197, 0xffff0000, v34
    v_lshlrev_b32 v208, 16, v42
    v_and_b32 v209, 0xffff0000, v42
    v_mul_f32 v196, v196, v62
    v_mul_f32 v197, v197, v62
    v_fmac_f32 v196, v208, v63
    v_fmac_f32 v197, v209, v63
    v_lshlrev_b32 v198, 16, v35
    v_and_b32 v199, 0xffff0000, v35
    v_lshlrev_b32 v208, 16, v43
    v_and_b32 v209, 0xffff0000, v43
    v_mul_f32 v198, v198, v62
    v_mul_f32 v199, v199, v62
    v_fmac_f32 v198, v208, v63
    v_fmac_f32 v199, v209, v63
    v_lshlrev_b32 v200, 16, v36
    v_and_b32 v201, 0xffff0000, v36
    v_lshlrev_b32 v208, 16, v44
    v_and_b32 v209, 0xffff0000, v44
    v_mul_f32 v200, v200, v62
    v_mul_f32 v201, v201, v62
    v_fmac_f32 v200, v208, v63
    v_fmac_f32 v201, v209, v63
    v_lshlrev_b32 v202, 16, v37
    v_and_b32 v203, 0xffff0000, v37
    v_lshlrev_b32 v208, 16, v45
    v_and_b32 v209, 0xffff0000, v45
    v_mul_f32 v202, v202, v62
    v_mul_f32 v203, v203, v62
    v_fmac_f32 v202, v208, v63
    v_fmac_f32 v203, v209, v63
    v_lshlrev_b32 v204, 16, v38
    v_and_b32 v205, 0xffff0000, v38
    v_lshlrev_b32 v208, 16, v46
    v_and_b32 v209, 0xffff0000, v46
    v_mul_f32 v204, v204, v62
    v_mul_f32 v205, v205, v62
    v_fmac_f32 v204, v208, v63
    v_fmac_f32 v205, v209, v63
    v_lshlrev_b32 v206, 16, v39
    v_and_b32 v207, 0xffff0000, v39
    v_lshlrev_b32 v208, 16, v47
    v_and_b32 v209, 0xffff0000, v47
    v_mul_f32 v206, v206, v62
    v_mul_f32 v207, v207, v62
    v_fmac_f32 v206, v208, v63
    v_fmac_f32 v207, v209, v63
    v_permlane32_swap_b32 v192, v200
    v_add_f32 v192, v192, v200
    v_permlane32_swap_b32 v193, v201
    v_add_f32 v193, v193, v201
    v_permlane32_swap_b32 v194, v202
    v_add_f32 v194, v194, v202
    v_permlane32_swap_b32 v195, v203
    v_add_f32 v195, v195, v203
    v_permlane32_swap_b32 v196, v204
    v_add_f32 v196, v196, v204
    v_permlane32_swap_b32 v197, v205
    v_add_f32 v197, v197, v205
    v_permlane32_swap_b32 v198, v206
    v_add_f32 v198, v198, v206
    v_permlane32_swap_b32 v199, v207
    v_add_f32 v199, v199, v207
    v_permlane16_swap_b32 v192, v196
    v_add_f32 v192, v192, v196
    v_permlane16_swap_b32 v193, v197
    v_add_f32 v193, v193, v197
    v_permlane16_swap_b32 v194, v198
    v_add_f32 v194, v194, v198
    v_permlane16_swap_b32 v195, v199
    v_add_f32 v195, v195, v199
    v_add_f32_dpp v192, v192, v192 row_ror:1 row_mask:0xf bank_mask:0xf
    v_add_f32_dpp v193, v193, v193 row_ror:1 row_mask:0xf bank_mask:0xf
    v_add_f32_dpp v194, v194, v194 row_ror:1 row_mask:0xf bank_mask:0xf
    v_add_f32_dpp v195, v195, v195 row_ror:1 row_mask:0xf bank_mask:0xf
    v_add_f32_dpp v192, v192, v192 row_ror:2 row_mask:0xf bank_mask:0xf
    v_add_f32_dpp v193, v193, v193 row_ror:2 row_mask:0xf bank_mask:0xf
    v_add_f32_dpp v194, v194, v194 row_ror:2 row_mask:0xf bank_mask:0xf
    v_add_f32_dpp v195, v195, v195 row_ror:2 row_mask:0xf bank_mask:0xf
    v_add_f32_dpp v192, v192, v192 row_ror:4 row_mask:0xf bank_mask:0xf
    v_add_f32_dpp v193, v193, v193 row_ror:4 row_mask:0xf bank_mask:0xf
    v_add_f32_dpp v194, v194, v194 row_ror:4 row_mask:0xf bank_mask:0xf
    v_add_f32_dpp v195, v195, v195 row_ror:4 row_mask:0xf bank_mask:0xf
    v_add_f32_dpp v192, v192, v192 row_ror:8 row_mask:0xf bank_mask:0xf
    v_add_f32_dpp v193, v193, v193 row_ror:8 row_mask:0xf bank_mask:0xf
    v_add_f32_dpp v194, v194, v194 row_ror:8 row_mask:0xf bank_mask:0xf
    v_add_f32_dpp v195, v195, v195 row_ror:8 row_mask:0xf bank_mask:0xf
    s_lshl_b32 s30, s3, 6
    v_lshlrev_b32 v10, 4, v3
    v_add_u32 v10, s30, v10
    v_cmp_eq_u32 vcc, 0, v2
    s_nop 0
    s_and_saveexec_b64 s[68:69], vcc
    ds_write_b128 v10, v[192:195] offset:8192
    s_mov_b64 exec, s[68:69]
    buffer_load_dwordx4 v[64:67], v4, s[16:19], s66 offen offset:0 nt
    buffer_load_dwordx4 v[68:71], v4, s[16:19], s66 offen offset:64 nt
    buffer_load_dwordx4 v[72:75], v4, s[16:19], s66 offen offset:128 nt
    buffer_load_dwordx4 v[76:79], v4, s[16:19], s66 offen offset:192 nt
    buffer_load_dwordx4 v[80:83], v5, s[16:19], s66 offen offset:0 nt
    buffer_load_dwordx4 v[84:87], v5, s[16:19], s66 offen offset:64 nt
    buffer_load_dwordx4 v[88:91], v5, s[16:19], s66 offen offset:128 nt
    buffer_load_dwordx4 v[92:95], v5, s[16:19], s66 offen offset:192 nt
    buffer_load_dwordx4 v[128:131], v6, s[20:23], s66 offen offset:0 nt
    buffer_load_dwordx4 v[132:135], v6, s[20:23], s66 offen offset:1024 nt
    buffer_load_dwordx4 v[136:139], v6, s[20:23], s66 offen offset:2048 nt
    buffer_load_dwordx4 v[140:143], v6, s[20:23], s66 offen offset:3072 nt
    buffer_load_dwordx4 v[144:147], v7, s[20:23], s66 offen offset:0 nt
    buffer_load_dwordx4 v[148:151], v7, s[20:23], s66 offen offset:1024 nt
    buffer_load_dwordx4 v[152:155], v7, s[20:23], s66 offen offset:2048 nt
    buffer_load_dwordx4 v[156:159], v7, s[20:23], s66 offen offset:3072 nt
    s_waitcnt vmcnt(8)
    buffer_load_dwordx4 v[96:99], v4, s[16:19], s67 offen offset:0 nt
    buffer_load_dwordx4 v[100:103], v4, s[16:19], s67 offen offset:64 nt
    buffer_load_dwordx4 v[104:107], v4, s[16:19], s67 offen offset:128 nt
    buffer_load_dwordx4 v[108:111], v4, s[16:19], s67 offen offset:192 nt
    buffer_load_dwordx4 v[112:115], v5, s[16:19], s67 offen offset:0 nt
    buffer_load_dwordx4 v[116:119], v5, s[16:19], s67 offen offset:64 nt
    buffer_load_dwordx4 v[120:123], v5, s[16:19], s67 offen offset:128 nt
    buffer_load_dwordx4 v[124:127], v5, s[16:19], s67 offen offset:192 nt
    s_waitcnt vmcnt(8)
    buffer_load_dwordx4 v[160:163], v6, s[20:23], s67 offen offset:0 nt
    buffer_load_dwordx4 v[164:167], v6, s[20:23], s67 offen offset:1024 nt
    buffer_load_dwordx4 v[168:171], v6, s[20:23], s67 offen offset:2048 nt
    buffer_load_dwordx4 v[172:175], v6, s[20:23], s67 offen offset:3072 nt
    buffer_load_dwordx4 v[176:179], v7, s[20:23], s67 offen offset:0 nt
    buffer_load_dwordx4 v[180:183], v7, s[20:23], s67 offen offset:1024 nt
    buffer_load_dwordx4 v[184:187], v7, s[20:23], s67 offen offset:2048 nt
    buffer_load_dwordx4 v[188:191], v7, s[20:23], s67 offen offset:3072 nt
    s_cmp_gt_u32 s3, 0
    s_nop 0
    s_cbranch_scc1 A_nol2
    s_waitcnt vmcnt(8)
    s_add_u32 s30, s77, 0
    s_mov_b32 m0, s30
    s_nop 0
    buffer_load_dwordx4 v6, s[16:19], s76 offen offset:0 nt lds
    buffer_load_dwordx4 v6, s[16:19], s76 offen offset:1024 nt lds
    buffer_load_dwordx4 v6, s[16:19], s76 offen offset:2048 nt lds
    buffer_load_dwordx4 v6, s[16:19], s76 offen offset:3072 nt lds
    s_add_u32 s30, s77, 4096
    s_mov_b32 m0, s30
    s_nop 0
    buffer_load_dwordx4 v7, s[16:19], s76 offen offset:0 nt lds
    buffer_load_dwordx4 v7, s[16:19], s76 offen offset:1024 nt lds
    buffer_load_dwordx4 v7, s[16:19], s76 offen offset:2048 nt lds
    buffer_load_dwordx4 v7, s[16:19], s76 offen offset:3072 nt lds
    s_waitcnt vmcnt(8)
    s_add_u32 s30, s77, 8192
    s_mov_b32 m0, s30
    s_nop 0
    buffer_load_dwordx4 v6, s[20:23], s76 offen offset:0 nt lds
    buffer_load_dwordx4 v6, s[20:23], s76 offen offset:1024 nt lds
    buffer_load_dwordx4 v6, s[20:23], s76 offen offset:2048 nt lds
    buffer_load_dwordx4 v6, s[20:23], s76 offen offset:3072 nt lds
    s_add_u32 s30, s77, 12288
    s_mov_b32 m0, s30
    s_nop 0
    buffer_load_dwordx4 v7, s[20:23], s76 offen offset:0 nt lds
    buffer_load_dwordx4 v7, s[20:23], s76 offen offset:1024 nt lds
    buffer_load_dwordx4 v7, s[20:23], s76 offen offset:2048 nt lds
    buffer_load_dwordx4 v7, s[20:23], s76 offen offset:3072 nt lds
A_nol2:
    s_waitcnt lgkmcnt(0)
    s_branch A_wait_q
A_w0:
    v_mov_b32 v10, 1028
    s_nop 4
A_spin:
    ds_read_b32 v11, v10
    s_waitcnt lgkmcnt(0)
    v_readfirstlane_b32 s30, v11
    s_nop 0
    s_cmp_lt_u32 s30, 3
    s_nop 2
    s_cbranch_scc1 A_spin
    v_and_b32 v10, 15, v1
    v_lshlrev_b32 v10, 2, v10
    ds_read_b32 v192, v10 offset:0
    ds_read_b32 v193, v10 offset:64
    ds_read_b32 v194, v10 offset:128
    ds_read_b32 v195, v10 offset:192
    s_lshl_b32 s30, s14, 5
    s_add_u32 s30, s30, s15
    s_lshl_b32 s30, s30, 6
    s_add_u32 s30, s30, 0
    v_lshlrev_b32 v11, 2, v1
    v_mov_b32 v203, s75
    s_waitcnt lgkmcnt(0)
    v_add_f32 v192, v192, v193
    v_add_f32 v192, v192, v194
    v_add_f32 v192, v192, v195
    s_nop 1
    v_mov_b32_dpp v200, v192 row_shl:1 row_mask:0xf bank_mask:0xf
    v_cvt_pk_bf16_f32 v202, v192, v200
    s_mov_b64 exec, 0x5555
    buffer_store_dwordx2 v[202:203], v11, s[24:27], s30 offen sc1
    s_mov_b64 exec, -1
    s_lshl_b32 s31, s64, 4
    s_cmp_ge_u32 s2, 224
    s_cselect_b32 s31, 0x7f000000, s31
    s_add_u32 s29, s31, 917504
    s_mov_b32 s65, 3584
    v_mul_lo_u32 v9, v0, s65
    buffer_load_dwordx4 v[32:35], v9, s[52:55], s31 offen
    buffer_load_dwordx4 v[36:39], v9, s[56:59], s31 offen
    buffer_load_dwordx4 v[40:43], v9, s[52:55], s29 offen
    buffer_load_dwordx4 v[44:47], v9, s[56:59], s29 offen
    s_waitcnt vmcnt(0)
    v_lshlrev_b32 v192, 16, v32
    v_and_b32 v193, 0xffff0000, v32
    v_lshlrev_b32 v208, 16, v40
    v_and_b32 v209, 0xffff0000, v40
    v_mul_f32 v192, v192, v62
    v_mul_f32 v193, v193, v62
    v_fmac_f32 v192, v208, v63
    v_fmac_f32 v193, v209, v63
    v_lshlrev_b32 v194, 16, v33
    v_and_b32 v195, 0xffff0000, v33
    v_lshlrev_b32 v208, 16, v41
    v_and_b32 v209, 0xffff0000, v41
    v_mul_f32 v194, v194, v62
    v_mul_f32 v195, v195, v62
    v_fmac_f32 v194, v208, v63
    v_fmac_f32 v195, v209, v63
    v_lshlrev_b32 v196, 16, v34
    v_and_b32 v197, 0xffff0000, v34
    v_lshlrev_b32 v208, 16, v42
    v_and_b32 v209, 0xffff0000, v42
    v_mul_f32 v196, v196, v62
    v_mul_f32 v197, v197, v62
    v_fmac_f32 v196, v208, v63
    v_fmac_f32 v197, v209, v63
    v_lshlrev_b32 v198, 16, v35
    v_and_b32 v199, 0xffff0000, v35
    v_lshlrev_b32 v208, 16, v43
    v_and_b32 v209, 0xffff0000, v43
    v_mul_f32 v198, v198, v62
    v_mul_f32 v199, v199, v62
    v_fmac_f32 v198, v208, v63
    v_fmac_f32 v199, v209, v63
    v_lshlrev_b32 v200, 16, v36
    v_and_b32 v201, 0xffff0000, v36
    v_lshlrev_b32 v208, 16, v44
    v_and_b32 v209, 0xffff0000, v44
    v_mul_f32 v200, v200, v62
    v_mul_f32 v201, v201, v62
    v_fmac_f32 v200, v208, v63
    v_fmac_f32 v201, v209, v63
    v_lshlrev_b32 v202, 16, v37
    v_and_b32 v203, 0xffff0000, v37
    v_lshlrev_b32 v208, 16, v45
    v_and_b32 v209, 0xffff0000, v45
    v_mul_f32 v202, v202, v62
    v_mul_f32 v203, v203, v62
    v_fmac_f32 v202, v208, v63
    v_fmac_f32 v203, v209, v63
    v_lshlrev_b32 v204, 16, v38
    v_and_b32 v205, 0xffff0000, v38
    v_lshlrev_b32 v208, 16, v46
    v_and_b32 v209, 0xffff0000, v46
    v_mul_f32 v204, v204, v62
    v_mul_f32 v205, v205, v62
    v_fmac_f32 v204, v208, v63
    v_fmac_f32 v205, v209, v63
    v_lshlrev_b32 v206, 16, v39
    v_and_b32 v207, 0xffff0000, v39
    v_lshlrev_b32 v208, 16, v47
    v_and_b32 v209, 0xffff0000, v47
    v_mul_f32 v206, v206, v62
    v_mul_f32 v207, v207, v62
    v_fmac_f32 v206, v208, v63
    v_fmac_f32 v207, v209, v63
    v_permlane32_swap_b32 v192, v200
    v_add_f32 v192, v192, v200
    v_permlane32_swap_b32 v193, v201
    v_add_f32 v193, v193, v201
    v_permlane32_swap_b32 v194, v202
    v_add_f32 v194, v194, v202
    v_permlane32_swap_b32 v195, v203
    v_add_f32 v195, v195, v203
    v_permlane32_swap_b32 v196, v204
    v_add_f32 v196, v196, v204
    v_permlane32_swap_b32 v197, v205
    v_add_f32 v197, v197, v205
    v_permlane32_swap_b32 v198, v206
    v_add_f32 v198, v198, v206
    v_permlane32_swap_b32 v199, v207
    v_add_f32 v199, v199, v207
    v_permlane16_swap_b32 v192, v196
    v_add_f32 v192, v192, v196
    v_permlane16_swap_b32 v193, v197
    v_add_f32 v193, v193, v197
    v_permlane16_swap_b32 v194, v198
    v_add_f32 v194, v194, v198
    v_permlane16_swap_b32 v195, v199
    v_add_f32 v195, v195, v199
    v_add_f32_dpp v192, v192, v192 row_ror:1 row_mask:0xf bank_mask:0xf
    v_add_f32_dpp v193, v193, v193 row_ror:1 row_mask:0xf bank_mask:0xf
    v_add_f32_dpp v194, v194, v194 row_ror:1 row_mask:0xf bank_mask:0xf
    v_add_f32_dpp v195, v195, v195 row_ror:1 row_mask:0xf bank_mask:0xf
    v_add_f32_dpp v192, v192, v192 row_ror:2 row_mask:0xf bank_mask:0xf
    v_add_f32_dpp v193, v193, v193 row_ror:2 row_mask:0xf bank_mask:0xf
    v_add_f32_dpp v194, v194, v194 row_ror:2 row_mask:0xf bank_mask:0xf
    v_add_f32_dpp v195, v195, v195 row_ror:2 row_mask:0xf bank_mask:0xf
    v_add_f32_dpp v192, v192, v192 row_ror:4 row_mask:0xf bank_mask:0xf
    v_add_f32_dpp v193, v193, v193 row_ror:4 row_mask:0xf bank_mask:0xf
    v_add_f32_dpp v194, v194, v194 row_ror:4 row_mask:0xf bank_mask:0xf
    v_add_f32_dpp v195, v195, v195 row_ror:4 row_mask:0xf bank_mask:0xf
    v_add_f32_dpp v192, v192, v192 row_ror:8 row_mask:0xf bank_mask:0xf
    v_add_f32_dpp v193, v193, v193 row_ror:8 row_mask:0xf bank_mask:0xf
    v_add_f32_dpp v194, v194, v194 row_ror:8 row_mask:0xf bank_mask:0xf
    v_add_f32_dpp v195, v195, v195 row_ror:8 row_mask:0xf bank_mask:0xf
    s_lshl_b32 s30, s3, 6
    v_lshlrev_b32 v10, 4, v3
    v_add_u32 v10, s30, v10
    v_cmp_eq_u32 vcc, 0, v2
    s_nop 0
    s_and_saveexec_b64 s[68:69], vcc
    ds_write_b128 v10, v[192:195] offset:8192
    s_mov_b64 exec, s[68:69]
    s_add_u32 s30, s14, 0
    s_and_b32 s30, s30, 7
    s_lshl_b32 s84, s30, 11
    s_mov_b32 s72, 0
    s_nop 0
A_poll:
    buffer_load_dwordx4 v[64:67], v6, s[24:27], s84 offen sc1
    buffer_load_dwordx4 v[68:71], v6, s[24:27], s84 offen offset:1024 sc1
    s_add_u32 s72, s72, 1
    s_waitcnt vmcnt(0)
    v_xor_b32 v10, s75, v65
    v_xor_b32 v11, s75, v67
    v_or_b32 v10, v10, v11
    v_xor_b32 v11, s75, v69
    v_or_b32 v10, v10, v11
    v_xor_b32 v11, s75, v71
    v_or_b32 v10, v10, v11
    v_cmp_ne_u32 vcc, 0, v10
    s_cmp_ge_u32 s72, 262144
    s_nop 3
    s_cbranch_scc1 A_pollend
    s_cbranch_vccnz A_poll
A_pollend:
    v_lshlrev_b32 v11, 3, v1
    v_add_u32 v11, 25088, v11
    v_mov_b32 v65, v66
    v_mov_b32 v69, v70
    ds_write_b64 v11, v[64:65] offset:0
    ds_write_b64 v11, v[68:69] offset:512
    s_waitcnt lgkmcnt(0)
    s_nop 1
A_wait_q:
    s_barrier
    s_cmp_lg_u32 s3, 1
    s_nop 0
    s_cbranch_scc1 A_noh
    s_cmp_ge_u32 s2, 224
    s_nop 0
    s_cbranch_scc1 A_noh
    v_and_b32 v10, 15, v1
    v_lshlrev_b32 v10, 2, v10
    ds_read_b32 v192, v10 offset:8192
    ds_read_b32 v193, v10 offset:8256
    ds_read_b32 v194, v10 offset:8320
    ds_read_b32 v195, v10 offset:8384
    s_waitcnt lgkmcnt(0)
    v_add_f32 v192, v192, v193
    v_add_f32 v192, v192, v194
    v_add_f32 v192, v192, v195
    v_cvt_pk_bf16_f32 v194, v192, v192
    v_lshlrev_b32 v194, 16, v194
    v_mov_b32 v195, 0
    s_nop 1
    v_mov_b32_dpp v195, v194 row_shl:8 row_mask:0xf bank_mask:0xf
    v_mul_f32 v196, 0xbfb8aa3b, v194
    v_min_f32 v196, 0x42fc0000, v196
    v_exp_f32 v196, v196
    s_nop 0
    v_add_f32 v196, 1.0, v196
    v_rcp_f32 v197, v196
    s_nop 0
    v_mul_f32 v198, v194, v197
    v_fma_f32 v199, -v198, v196, v194
    v_fma_f32 v198, v199, v197, v198
    v_cvt_pk_bf16_f32 v198, v198, v198
    v_lshlrev_b32 v198, 16, v198
    v_mul_f32 v198, v198, v195
    s_nop 1
    v_mov_b32_dpp v200, v198 row_shl:1 row_mask:0xf bank_mask:0xf
    v_cvt_pk_bf16_f32 v204, v198, v200
    v_mov_b32 v205, s75
    s_lshl_b32 s31, s64, 5
    s_add_u32 s31, s31, 16384
    v_lshlrev_b32 v11, 2, v1
    s_mov_b64 exec, 0x55
    buffer_store_dwordx2 v[204:205], v11, s[24:27], s31 offen sc1
    s_mov_b64 exec, -1
    s_nop 1
A_noh:
    v_and_b32 v10, 3, v2
    v_lshlrev_b32 v10, 8, v10
    v_lshlrev_b32 v11, 4, v3
    v_add_u32 v10, v10, v11
    s_lshl_b32 s30, s62, 10
    s_add_u32 s30, s30, 25088
    v_add_u32 v10, s30, v10
    ds_read_b128 v[192:195], v10 offset:0
    ds_read_b128 v[196:199], v10 offset:64
    ds_read_b128 v[200:203], v10 offset:128
    ds_read_b128 v[204:207], v10 offset:192
    v_mov_b32 v8, 0xff800000
    v_mov_b32 v9, 0
    v_mov_b32 v208, 0
    v_mov_b32 v209, 0
    v_mov_b32 v210, 0
    v_mov_b32 v211, 0
    v_mov_b32 v212, 0
    v_mov_b32 v213, 0
    v_mov_b32 v214, 0
    v_mov_b32 v215, 0
    v_mov_b32 v216, 0
    v_mov_b32 v217, 0
    v_mov_b32 v218, 0
    v_mov_b32 v219, 0
    v_mov_b32 v220, 0
    v_mov_b32 v221, 0
    v_mov_b32 v222, 0
    v_mov_b32 v223, 0
    v_mov_b32 v224, 0
    v_mov_b32 v225, 0
    v_mov_b32 v226, 0
    v_mov_b32 v227, 0
    v_mov_b32 v228, 0
    v_mov_b32 v229, 0
    v_mov_b32 v230, 0
    v_mov_b32 v231, 0
    v_mov_b32 v232, 0
    v_mov_b32 v233, 0
    v_mov_b32 v234, 0
    v_mov_b32 v235, 0
    v_mov_b32 v236, 0
    v_mov_b32 v237, 0
    v_mov_b32 v238, 0
    v_mov_b32 v239, 0
    v_cmp_gt_u32 vcc, 4, v2
    s_waitcnt lgkmcnt(0)
    s_nop 0
    v_cndmask_b32 v192, 0, v192, vcc
    v_cndmask_b32 v193, 0, v193, vcc
    v_cndmask_b32 v194, 0, v194, vcc
    v_cndmask_b32 v195, 0, v195, vcc
    v_cndmask_b32 v196, 0, v196, vcc
    v_cndmask_b32 v197, 0, v197, vcc
    v_cndmask_b32 v198, 0, v198, vcc
    v_cndmask_b32 v199, 0, v199, vcc
    v_cndmask_b32 v200, 0, v200, vcc
    v_cndmask_b32 v201, 0, v201, vcc
    v_cndmask_b32 v202, 0, v202, vcc
    v_cndmask_b32 v203, 0, v203, vcc
    v_cndmask_b32 v204, 0, v204, vcc
    v_cndmask_b32 v205, 0, v205, vcc
    v_cndmask_b32 v206, 0, v206, vcc
    v_cndmask_b32 v207, 0, v207, vcc
    v_mov_b32 v56, 1024
    v_mov_b32 v57, 1
    s_cmp_lg_u32 s3, 0
    s_nop 3
    s_cbranch_scc1 A_loop
    s_cmp_ge_u32 s2, 112
    s_nop 0
    s_cbranch_scc1 A_now2
    s_mov_b32 s52, s80
    s_and_b32 s53, s81, 0xffff
    s_mov_b32 s54, 0x1c0000
    s_mov_b32 s55, 0x20000
    v_lshrrev_b32 v58, 3, v1
    v_lshlrev_b32 v59, 10, v58
    v_and_b32 v60, 7, v1
    v_lshlrev_b32 v60, 4, v60
    v_add_u32 v59, v59, v60
    s_lshl_b32 s30, s15, 17
    s_lshl_b32 s31, s14, 7
    s_add_u32 s30, s30, s31
    buffer_load_dwordx4 v[64:67], v59, s[52:55], s30 offen
    s_add_u32 s30, s30, 0x2000
    buffer_load_dwordx4 v[68:71], v59, s[52:55], s30 offen
    s_add_u32 s30, s30, 0x2000
    buffer_load_dwordx4 v[72:75], v59, s[52:55], s30 offen
    s_add_u32 s30, s30, 0x2000
    buffer_load_dwordx4 v[76:79], v59, s[52:55], s30 offen
    s_add_u32 s30, s30, 0x2000
    buffer_load_dwordx4 v[80:83], v59, s[52:55], s30 offen
    s_add_u32 s30, s30, 0x2000
    buffer_load_dwordx4 v[84:87], v59, s[52:55], s30 offen
    s_add_u32 s30, s30, 0x2000
    buffer_load_dwordx4 v[88:91], v59, s[52:55], s30 offen
    s_add_u32 s30, s30, 0x2000
    buffer_load_dwordx4 v[92:95], v59, s[52:55], s30 offen
    s_add_u32 s30, s30, 0x2000
    buffer_load_dwordx4 v[96:99], v59, s[52:55], s30 offen
    s_add_u32 s30, s30, 0x2000
    buffer_load_dwordx4 v[100:103], v59, s[52:55], s30 offen
    s_add_u32 s30, s30, 0x2000
    buffer_load_dwordx4 v[104:107], v59, s[52:55], s30 offen
    s_add_u32 s30, s30, 0x2000
    buffer_load_dwordx4 v[108:111], v59, s[52:55], s30 offen
    s_add_u32 s30, s30, 0x2000
    buffer_load_dwordx4 v[112:115], v59, s[52:55], s30 offen
    s_add_u32 s30, s30, 0x2000
    buffer_load_dwordx4 v[116:119], v59, s[52:55], s30 offen
    s_add_u32 s30, s30, 0x2000
    buffer_load_dwordx4 v[120:123], v59, s[52:55], s30 offen
    s_add_u32 s30, s30, 0x2000
    buffer_load_dwordx4 v[124:127], v59, s[52:55], s30 offen
    s_lshl_b32 s30, s15, 9
    s_add_u32 s30, s30, 16384
    v_lshlrev_b32 v60, 3, v1
    s_mov_b32 s72, 0
    s_nop 3
A_pollh:
    buffer_load_dwordx2 v[128:129], v60, s[24:27], s30 offen sc1
    s_add_u32 s72, s72, 1
    s_waitcnt vmcnt(0)
    v_cmp_ne_u32 vcc, s75, v129
    s_cmp_ge_u32 s72, 262144
    s_nop 3
    s_cbranch_scc1 A_pollhend
    s_cbranch_vccz A_pollhend
    s_sleep 8
    s_branch A_pollh
A_pollhend:
    v_lshlrev_b32 v130, 16, v128
    v_and_b32 v131, 0xffff0000, v128
    ds_write_b64 v60, v[130:131] offset:1536
    v_lshlrev_b32 v58, 2, v58
    s_waitcnt lgkmcnt(0)
    ds_read_b32 v132, v58 offset:1536
    ds_read_b32 v133, v58 offset:1568
    ds_read_b32 v134, v58 offset:1600
    ds_read_b32 v135, v58 offset:1632
    ds_read_b32 v136, v58 offset:1664
    ds_read_b32 v137, v58 offset:1696
    ds_read_b32 v138, v58 offset:1728
    ds_read_b32 v139, v58 offset:1760
    ds_read_b32 v140, v58 offset:1792
    ds_read_b32 v141, v58 offset:1824
    ds_read_b32 v142, v58 offset:1856
    ds_read_b32 v143, v58 offset:1888
    ds_read_b32 v144, v58 offset:1920
    ds_read_b32 v145, v58 offset:1952
    ds_read_b32 v146, v58 offset:1984
    ds_read_b32 v147, v58 offset:2016
    s_waitcnt lgkmcnt(0)
    v_lshlrev_b32 v156, 16, v64
    v_and_b32 v157, 0xffff0000, v64
    v_mul_f32 v148, v156, v132
    v_mul_f32 v149, v157, v132
    v_lshlrev_b32 v156, 16, v65
    v_and_b32 v157, 0xffff0000, v65
    v_mul_f32 v150, v156, v132
    v_mul_f32 v151, v157, v132
    v_lshlrev_b32 v156, 16, v66
    v_and_b32 v157, 0xffff0000, v66
    v_mul_f32 v152, v156, v132
    v_mul_f32 v153, v157, v132
    v_lshlrev_b32 v156, 16, v67
    v_and_b32 v157, 0xffff0000, v67
    v_mul_f32 v154, v156, v132
    v_mul_f32 v155, v157, v132
    v_lshlrev_b32 v156, 16, v68
    v_and_b32 v157, 0xffff0000, v68
    v_fmac_f32 v148, v156, v133
    v_fmac_f32 v149, v157, v133
    v_lshlrev_b32 v156, 16, v69
    v_and_b32 v157, 0xffff0000, v69
    v_fmac_f32 v150, v156, v133
    v_fmac_f32 v151, v157, v133
    v_lshlrev_b32 v156, 16, v70
    v_and_b32 v157, 0xffff0000, v70
    v_fmac_f32 v152, v156, v133
    v_fmac_f32 v153, v157, v133
    v_lshlrev_b32 v156, 16, v71
    v_and_b32 v157, 0xffff0000, v71
    v_fmac_f32 v154, v156, v133
    v_fmac_f32 v155, v157, v133
    v_lshlrev_b32 v156, 16, v72
    v_and_b32 v157, 0xffff0000, v72
    v_fmac_f32 v148, v156, v134
    v_fmac_f32 v149, v157, v134
    v_lshlrev_b32 v156, 16, v73
    v_and_b32 v157, 0xffff0000, v73
    v_fmac_f32 v150, v156, v134
    v_fmac_f32 v151, v157, v134
    v_lshlrev_b32 v156, 16, v74
    v_and_b32 v157, 0xffff0000, v74
    v_fmac_f32 v152, v156, v134
    v_fmac_f32 v153, v157, v134
    v_lshlrev_b32 v156, 16, v75
    v_and_b32 v157, 0xffff0000, v75
    v_fmac_f32 v154, v156, v134
    v_fmac_f32 v155, v157, v134
    v_lshlrev_b32 v156, 16, v76
    v_and_b32 v157, 0xffff0000, v76
    v_fmac_f32 v148, v156, v135
    v_fmac_f32 v149, v157, v135
    v_lshlrev_b32 v156, 16, v77
    v_and_b32 v157, 0xffff0000, v77
    v_fmac_f32 v150, v156, v135
    v_fmac_f32 v151, v157, v135
    v_lshlrev_b32 v156, 16, v78
    v_and_b32 v157, 0xffff0000, v78
    v_fmac_f32 v152, v156, v135
    v_fmac_f32 v153, v157, v135
    v_lshlrev_b32 v156, 16, v79
    v_and_b32 v157, 0xffff0000, v79
    v_fmac_f32 v154, v156, v135
    v_fmac_f32 v155, v157, v135
    v_lshlrev_b32 v156, 16, v80
    v_and_b32 v157, 0xffff0000, v80
    v_fmac_f32 v148, v156, v136
    v_fmac_f32 v149, v157, v136
    v_lshlrev_b32 v156, 16, v81
    v_and_b32 v157, 0xffff0000, v81
    v_fmac_f32 v150, v156, v136
    v_fmac_f32 v151, v157, v136
    v_lshlrev_b32 v156, 16, v82
    v_and_b32 v157, 0xffff0000, v82
    v_fmac_f32 v152, v156, v136
    v_fmac_f32 v153, v157, v136
    v_lshlrev_b32 v156, 16, v83
    v_and_b32 v157, 0xffff0000, v83
    v_fmac_f32 v154, v156, v136
    v_fmac_f32 v155, v157, v136
    v_lshlrev_b32 v156, 16, v84
    v_and_b32 v157, 0xffff0000, v84
    v_fmac_f32 v148, v156, v137
    v_fmac_f32 v149, v157, v137
    v_lshlrev_b32 v156, 16, v85
    v_and_b32 v157, 0xffff0000, v85
    v_fmac_f32 v150, v156, v137
    v_fmac_f32 v151, v157, v137
    v_lshlrev_b32 v156, 16, v86
    v_and_b32 v157, 0xffff0000, v86
    v_fmac_f32 v152, v156, v137
    v_fmac_f32 v153, v157, v137
    v_lshlrev_b32 v156, 16, v87
    v_and_b32 v157, 0xffff0000, v87
    v_fmac_f32 v154, v156, v137
    v_fmac_f32 v155, v157, v137
    v_lshlrev_b32 v156, 16, v88
    v_and_b32 v157, 0xffff0000, v88
    v_fmac_f32 v148, v156, v138
    v_fmac_f32 v149, v157, v138
    v_lshlrev_b32 v156, 16, v89
    v_and_b32 v157, 0xffff0000, v89
    v_fmac_f32 v150, v156, v138
    v_fmac_f32 v151, v157, v138
    v_lshlrev_b32 v156, 16, v90
    v_and_b32 v157, 0xffff0000, v90
    v_fmac_f32 v152, v156, v138
    v_fmac_f32 v153, v157, v138
    v_lshlrev_b32 v156, 16, v91
    v_and_b32 v157, 0xffff0000, v91
    v_fmac_f32 v154, v156, v138
    v_fmac_f32 v155, v157, v138
    v_lshlrev_b32 v156, 16, v92
    v_and_b32 v157, 0xffff0000, v92
    v_fmac_f32 v148, v156, v139
    v_fmac_f32 v149, v157, v139
    v_lshlrev_b32 v156, 16, v93
    v_and_b32 v157, 0xffff0000, v93
    v_fmac_f32 v150, v156, v139
    v_fmac_f32 v151, v157, v139
    v_lshlrev_b32 v156, 16, v94
    v_and_b32 v157, 0xffff0000, v94
    v_fmac_f32 v152, v156, v139
    v_fmac_f32 v153, v157, v139
    v_lshlrev_b32 v156, 16, v95
    v_and_b32 v157, 0xffff0000, v95
    v_fmac_f32 v154, v156, v139
    v_fmac_f32 v155, v157, v139
    v_lshlrev_b32 v156, 16, v96
    v_and_b32 v157, 0xffff0000, v96
    v_fmac_f32 v148, v156, v140
    v_fmac_f32 v149, v157, v140
    v_lshlrev_b32 v156, 16, v97
    v_and_b32 v157, 0xffff0000, v97
    v_fmac_f32 v150, v156, v140
    v_fmac_f32 v151, v157, v140
    v_lshlrev_b32 v156, 16, v98
    v_and_b32 v157, 0xffff0000, v98
    v_fmac_f32 v152, v156, v140
    v_fmac_f32 v153, v157, v140
    v_lshlrev_b32 v156, 16, v99
    v_and_b32 v157, 0xffff0000, v99
    v_fmac_f32 v154, v156, v140
    v_fmac_f32 v155, v157, v140
    v_lshlrev_b32 v156, 16, v100
    v_and_b32 v157, 0xffff0000, v100
    v_fmac_f32 v148, v156, v141
    v_fmac_f32 v149, v157, v141
    v_lshlrev_b32 v156, 16, v101
    v_and_b32 v157, 0xffff0000, v101
    v_fmac_f32 v150, v156, v141
    v_fmac_f32 v151, v157, v141
    v_lshlrev_b32 v156, 16, v102
    v_and_b32 v157, 0xffff0000, v102
    v_fmac_f32 v152, v156, v141
    v_fmac_f32 v153, v157, v141
    v_lshlrev_b32 v156, 16, v103
    v_and_b32 v157, 0xffff0000, v103
    v_fmac_f32 v154, v156, v141
    v_fmac_f32 v155, v157, v141
    v_lshlrev_b32 v156, 16, v104
    v_and_b32 v157, 0xffff0000, v104
    v_fmac_f32 v148, v156, v142
    v_fmac_f32 v149, v157, v142
    v_lshlrev_b32 v156, 16, v105
    v_and_b32 v157, 0xffff0000, v105
    v_fmac_f32 v150, v156, v142
    v_fmac_f32 v151, v157, v142
    v_lshlrev_b32 v156, 16, v106
    v_and_b32 v157, 0xffff0000, v106
    v_fmac_f32 v152, v156, v142
    v_fmac_f32 v153, v157, v142
    v_lshlrev_b32 v156, 16, v107
    v_and_b32 v157, 0xffff0000, v107
    v_fmac_f32 v154, v156, v142
    v_fmac_f32 v155, v157, v142
    v_lshlrev_b32 v156, 16, v108
    v_and_b32 v157, 0xffff0000, v108
    v_fmac_f32 v148, v156, v143
    v_fmac_f32 v149, v157, v143
    v_lshlrev_b32 v156, 16, v109
    v_and_b32 v157, 0xffff0000, v109
    v_fmac_f32 v150, v156, v143
    v_fmac_f32 v151, v157, v143
    v_lshlrev_b32 v156, 16, v110
    v_and_b32 v157, 0xffff0000, v110
    v_fmac_f32 v152, v156, v143
    v_fmac_f32 v153, v157, v143
    v_lshlrev_b32 v156, 16, v111
    v_and_b32 v157, 0xffff0000, v111
    v_fmac_f32 v154, v156, v143
    v_fmac_f32 v155, v157, v143
    v_lshlrev_b32 v156, 16, v112
    v_and_b32 v157, 0xffff0000, v112
    v_fmac_f32 v148, v156, v144
    v_fmac_f32 v149, v157, v144
    v_lshlrev_b32 v156, 16, v113
    v_and_b32 v157, 0xffff0000, v113
    v_fmac_f32 v150, v156, v144
    v_fmac_f32 v151, v157, v144
    v_lshlrev_b32 v156, 16, v114
    v_and_b32 v157, 0xffff0000, v114
    v_fmac_f32 v152, v156, v144
    v_fmac_f32 v153, v157, v144
    v_lshlrev_b32 v156, 16, v115
    v_and_b32 v157, 0xffff0000, v115
    v_fmac_f32 v154, v156, v144
    v_fmac_f32 v155, v157, v144
    v_lshlrev_b32 v156, 16, v116
    v_and_b32 v157, 0xffff0000, v116
    v_fmac_f32 v148, v156, v145
    v_fmac_f32 v149, v157, v145
    v_lshlrev_b32 v156, 16, v117
    v_and_b32 v157, 0xffff0000, v117
    v_fmac_f32 v150, v156, v145
    v_fmac_f32 v151, v157, v145
    v_lshlrev_b32 v156, 16, v118
    v_and_b32 v157, 0xffff0000, v118
    v_fmac_f32 v152, v156, v145
    v_fmac_f32 v153, v157, v145
    v_lshlrev_b32 v156, 16, v119
    v_and_b32 v157, 0xffff0000, v119
    v_fmac_f32 v154, v156, v145
    v_fmac_f32 v155, v157, v145
    v_lshlrev_b32 v156, 16, v120
    v_and_b32 v157, 0xffff0000, v120
    v_fmac_f32 v148, v156, v146
    v_fmac_f32 v149, v157, v146
    v_lshlrev_b32 v156, 16, v121
    v_and_b32 v157, 0xffff0000, v121
    v_fmac_f32 v150, v156, v146
    v_fmac_f32 v151, v157, v146
    v_lshlrev_b32 v156, 16, v122
    v_and_b32 v157, 0xffff0000, v122
    v_fmac_f32 v152, v156, v146
    v_fmac_f32 v153, v157, v146
    v_lshlrev_b32 v156, 16, v123
    v_and_b32 v157, 0xffff0000, v123
    v_fmac_f32 v154, v156, v146
    v_fmac_f32 v155, v157, v146
    v_lshlrev_b32 v156, 16, v124
    v_and_b32 v157, 0xffff0000, v124
    v_fmac_f32 v148, v156, v147
    v_fmac_f32 v149, v157, v147
    v_lshlrev_b32 v156, 16, v125
    v_and_b32 v157, 0xffff0000, v125
    v_fmac_f32 v150, v156, v147
    v_fmac_f32 v151, v157, v147
    v_lshlrev_b32 v156, 16, v126
    v_and_b32 v157, 0xffff0000, v126
    v_fmac_f32 v152, v156, v147
    v_fmac_f32 v153, v157, v147
    v_lshlrev_b32 v156, 16, v127
    v_and_b32 v157, 0xffff0000, v127
    v_fmac_f32 v154, v156, v147
    v_fmac_f32 v155, v157, v147
    v_add_f32_dpp v148, v148, v148 row_ror:8 row_mask:0xf bank_mask:0xf
    v_add_f32_dpp v149, v149, v149 row_ror:8 row_mask:0xf bank_mask:0xf
    v_add_f32_dpp v150, v150, v150 row_ror:8 row_mask:0xf bank_mask:0xf
    v_add_f32_dpp v151, v151, v151 row_ror:8 row_mask:0xf bank_mask:0xf
    v_add_f32_dpp v152, v152, v152 row_ror:8 row_mask:0xf bank_mask:0xf
    v_add_f32_dpp v153, v153, v153 row_ror:8 row_mask:0xf bank_mask:0xf
    v_add_f32_dpp v154, v154, v154 row_ror:8 row_mask:0xf bank_mask:0xf
    v_add_f32_dpp v155, v155, v155 row_ror:8 row_mask:0xf bank_mask:0xf
    v_permlane32_swap_b32 v148, v152
    v_add_f32 v148, v148, v152
    v_permlane32_swap_b32 v149, v153
    v_add_f32 v149, v149, v153
    v_permlane32_swap_b32 v150, v154
    v_add_f32 v150, v150, v154
    v_permlane32_swap_b32 v151, v155
    v_add_f32 v151, v151, v155
    v_permlane16_swap_b32 v148, v150
    v_add_f32 v148, v148, v150
    v_permlane16_swap_b32 v149, v151
    v_add_f32 v149, v149, v151
    v_mov_b32 v151, s75
    v_mov_b32 v150, v149
    v_mov_b32 v149, s75
    v_and_b32 v58, 7, v1
    v_lshlrev_b32 v58, 6, v58
    v_lshlrev_b32 v59, 4, v3
    v_add_u32 v58, v58, v59
    s_mul_i32 s30, s14, 46
    s_add_u32 s30, s30, s15
    s_add_u32 s30, s30, 32
    s_lshl_b32 s30, s30, 9
    s_add_u32 s30, s30, 9437184
    v_cmp_gt_u32 vcc, 8, v2
    s_nop 0
    s_and_saveexec_b64 s[68:69], vcc
    buffer_store_dwordx2 v[148:149], v58, s[24:27], s30 offen sc1
    buffer_store_dwordx2 v[150:151], v58, s[24:27], s30 offen offset:8 sc1
    s_mov_b64 exec, s[68:69]
    s_nop 0
A_now2:
    s_mov_b64 exec, 1
    ds_add_rtn_u32 v15, v56, v57
    s_mov_b64 exec, -1
    s_waitcnt lgkmcnt(0)
    v_readfirstlane_b32 s73, v15
    s_mov_b32 s60, 0
    s_add_u32 s66, s73, s28
    s_lshl_b32 s66, s66, 13
    s_lshl_b32 s63, s14, 24
    s_add_u32 s66, s66, s63
    s_cmp_ge_u32 s73, s93
    s_nop 0
    s_cbranch_scc1 A_done
    buffer_load_dwordx4 v[64:67], v4, s[16:19], s66 offen offset:0 nt
    buffer_load_dwordx4 v[68:71], v4, s[16:19], s66 offen offset:64 nt
    buffer_load_dwordx4 v[72:75], v4, s[16:19], s66 offen offset:128 nt
    buffer_load_dwordx4 v[76:79], v4, s[16:19], s66 offen offset:192 nt
    buffer_load_dwordx4 v[80:83], v5, s[16:19], s66 offen offset:0 nt
    buffer_load_dwordx4 v[84:87], v5, s[16:19], s66 offen offset:64 nt
    buffer_load_dwordx4 v[88:91], v5, s[16:19], s66 offen offset:128 nt
    buffer_load_dwordx4 v[92:95], v5, s[16:19], s66 offen offset:192 nt
    buffer_load_dwordx4 v[128:131], v6, s[20:23], s66 offen offset:0 nt
    buffer_load_dwordx4 v[132:135], v6, s[20:23], s66 offen offset:1024 nt
    buffer_load_dwordx4 v[136:139], v6, s[20:23], s66 offen offset:2048 nt
    buffer_load_dwordx4 v[140:143], v6, s[20:23], s66 offen offset:3072 nt
    buffer_load_dwordx4 v[144:147], v7, s[20:23], s66 offen offset:0 nt
    buffer_load_dwordx4 v[148:151], v7, s[20:23], s66 offen offset:1024 nt
    buffer_load_dwordx4 v[152:155], v7, s[20:23], s66 offen offset:2048 nt
    buffer_load_dwordx4 v[156:159], v7, s[20:23], s66 offen offset:3072 nt
    s_mov_b64 exec, 1
    ds_add_rtn_u32 v15, v56, v57
    s_mov_b64 exec, -1
    s_waitcnt lgkmcnt(0)
    v_readfirstlane_b32 s73, v15
    s_mov_b32 s61, 0
    s_add_u32 s67, s73, s28
    s_lshl_b32 s67, s67, 13
    s_lshl_b32 s63, s14, 24
    s_add_u32 s67, s67, s63
    s_cmp_ge_u32 s73, s93
    s_nop 0
    s_cbranch_scc1 A_fullA
    buffer_load_dwordx4 v[96:99], v4, s[16:19], s67 offen offset:0 nt
    buffer_load_dwordx4 v[100:103], v4, s[16:19], s67 offen offset:64 nt
    buffer_load_dwordx4 v[104:107], v4, s[16:19], s67 offen offset:128 nt
    buffer_load_dwordx4 v[108:111], v4, s[16:19], s67 offen offset:192 nt
    buffer_load_dwordx4 v[112:115], v5, s[16:19], s67 offen offset:0 nt
    buffer_load_dwordx4 v[116:119], v5, s[16:19], s67 offen offset:64 nt
    buffer_load_dwordx4 v[120:123], v5, s[16:19], s67 offen offset:128 nt
    buffer_load_dwordx4 v[124:127], v5, s[16:19], s67 offen offset:192 nt
    buffer_load_dwordx4 v[160:163], v6, s[20:23], s67 offen offset:0 nt
    buffer_load_dwordx4 v[164:167], v6, s[20:23], s67 offen offset:1024 nt
    buffer_load_dwordx4 v[168:171], v6, s[20:23], s67 offen offset:2048 nt
    buffer_load_dwordx4 v[172:175], v6, s[20:23], s67 offen offset:3072 nt
    buffer_load_dwordx4 v[176:179], v7, s[20:23], s67 offen offset:0 nt
    buffer_load_dwordx4 v[180:183], v7, s[20:23], s67 offen offset:1024 nt
    buffer_load_dwordx4 v[184:187], v7, s[20:23], s67 offen offset:2048 nt
    buffer_load_dwordx4 v[188:191], v7, s[20:23], s67 offen offset:3072 nt
A_loop:
    s_mov_b64 exec, 1
    ds_add_rtn_u32 v15, v56, v57
    s_mov_b64 exec, -1
    s_waitcnt vmcnt(24)
A_ck1:
    s_cmp_ge_u32 s62, s60
    s_nop 0
    s_cbranch_scc1 A_ck1e
    s_swappc_b64 s[100:101], s[98:99]
    s_nop 0
    s_branch A_ck1
A_ck1e:
    v_mfma_f32_16x16x32_bf16 v[240:243], v[64:67], v[192:195], 0
    v_mfma_f32_16x16x32_bf16 v[240:243], v[68:71], v[196:199], v[240:243]
    v_mfma_f32_16x16x32_bf16 v[240:243], v[72:75], v[200:203], v[240:243]
    v_mfma_f32_16x16x32_bf16 v[240:243], v[76:79], v[204:207], v[240:243]
    v_mfma_f32_16x16x32_bf16 v[244:247], v[80:83], v[192:195], 0
    v_mfma_f32_16x16x32_bf16 v[244:247], v[84:87], v[196:199], v[244:247]
    v_mfma_f32_16x16x32_bf16 v[244:247], v[88:91], v[200:203], v[244:247]
    v_mfma_f32_16x16x32_bf16 v[244:247], v[92:95], v[204:207], v[244:247]
    s_waitcnt lgkmcnt(0)
    v_readfirstlane_b32 s73, v15
    s_mov_b32 s60, 0
    s_add_u32 s66, s73, s28
    s_lshl_b32 s66, s66, 13
    s_lshl_b32 s63, s14, 24
    s_add_u32 s66, s66, s63
    s_cmp_ge_u32 s73, s93
    s_nop 0
    s_cbranch_scc1 A_drainA
    buffer_load_dwordx4 v[64:67], v4, s[16:19], s66 offen offset:0 nt
    buffer_load_dwordx4 v[68:71], v4, s[16:19], s66 offen offset:64 nt
    buffer_load_dwordx4 v[72:75], v4, s[16:19], s66 offen offset:128 nt
    buffer_load_dwordx4 v[76:79], v4, s[16:19], s66 offen offset:192 nt
    buffer_load_dwordx4 v[80:83], v5, s[16:19], s66 offen offset:0 nt
    buffer_load_dwordx4 v[84:87], v5, s[16:19], s66 offen offset:64 nt
    buffer_load_dwordx4 v[88:91], v5, s[16:19], s66 offen offset:128 nt
    buffer_load_dwordx4 v[92:95], v5, s[16:19], s66 offen offset:192 nt
    v_cvt_pk_bf16_f32 v10, v240, v241
    v_lshlrev_b32 v11, 16, v10
    v_and_b32 v12, 0xffff0000, v10
    v_mul_f32 v11, s35, v11
    v_mul_f32 v12, s35, v12
    v_cvt_pk_bf16_f32 v10, v11, v12
    v_lshlrev_b32 v48, 16, v10
    v_and_b32 v49, 0xffff0000, v10
    v_cvt_pk_bf16_f32 v10, v242, v243
    v_lshlrev_b32 v11, 16, v10
    v_and_b32 v12, 0xffff0000, v10
    v_mul_f32 v11, s35, v11
    v_mul_f32 v12, s35, v12
    v_cvt_pk_bf16_f32 v10, v11, v12
    v_lshlrev_b32 v50, 16, v10
    v_and_b32 v51, 0xffff0000, v10
    v_cvt_pk_bf16_f32 v10, v244, v245
    v_lshlrev_b32 v11, 16, v10
    v_and_b32 v12, 0xffff0000, v10
    v_mul_f32 v11, s35, v11
    v_mul_f32 v12, s35, v12
    v_cvt_pk_bf16_f32 v10, v11, v12
    v_lshlrev_b32 v52, 16, v10
    v_and_b32 v53, 0xffff0000, v10
    v_cvt_pk_bf16_f32 v10, v246, v247
    v_lshlrev_b32 v11, 16, v10
    v_and_b32 v12, 0xffff0000, v10
    v_mul_f32 v11, s35, v11
    v_mul_f32 v12, s35, v12
    v_cvt_pk_bf16_f32 v10, v11, v12
    v_lshlrev_b32 v54, 16, v10
    v_and_b32 v55, 0xffff0000, v10
    v_max3_f32 v10, v48, v49, v50
    v_max3_f32 v10, v10, v51, v52
    v_max3_f32 v10, v10, v53, v54
    v_max3_f32 v10, v10, v55, v8
    v_mov_b32 v11, v10
    s_nop 1
    v_permlane16_swap_b32 v10, v11
    v_max_f32 v10, v10, v11
    v_mov_b32 v11, v10
    s_nop 1
    v_permlane32_swap_b32 v10, v11
    v_max_f32 v10, v10, v11
    v_sub_f32 v14, v8, v10
    v_mul_f32 v14, s34, v14
    v_exp_f32 v14, v14
    v_mov_b32 v8, v10
    v_mul_f32 v13, s34, v10
    v_fma_f32 v48, v48, s34, -v13
    v_exp_f32 v48, v48
    v_fma_f32 v49, v49, s34, -v13
    v_exp_f32 v49, v49
    v_fma_f32 v50, v50, s34, -v13
    v_exp_f32 v50, v50
    v_fma_f32 v51, v51, s34, -v13
    v_exp_f32 v51, v51
    v_fma_f32 v52, v52, s34, -v13
    v_exp_f32 v52, v52
    v_fma_f32 v53, v53, s34, -v13
    v_exp_f32 v53, v53
    v_fma_f32 v54, v54, s34, -v13
    v_exp_f32 v54, v54
    v_fma_f32 v55, v55, s34, -v13
    v_exp_f32 v55, v55
    v_mul_f32 v9, v9, v14
    v_add_f32 v9, v9, v48
    v_add_f32 v9, v9, v49
    v_add_f32 v9, v9, v50
    v_add_f32 v9, v9, v51
    v_add_f32 v9, v9, v52
    v_add_f32 v9, v9, v53
    v_add_f32 v9, v9, v54
    v_add_f32 v9, v9, v55
    v_cvt_pk_bf16_f32 v248, v48, v49
    v_cvt_pk_bf16_f32 v249, v50, v51
    v_cvt_pk_bf16_f32 v250, v52, v53
    v_cvt_pk_bf16_f32 v251, v54, v55
    v_mul_f32 v208, v208, v14
    v_mul_f32 v209, v209, v14
    v_mul_f32 v210, v210, v14
    v_mul_f32 v211, v211, v14
    v_mul_f32 v212, v212, v14
    v_mul_f32 v213, v213, v14
    v_mul_f32 v214, v214, v14
    v_mul_f32 v215, v215, v14
    v_mul_f32 v216, v216, v14
    v_mul_f32 v217, v217, v14
    v_mul_f32 v218, v218, v14
    v_mul_f32 v219, v219, v14
    v_mul_f32 v220, v220, v14
    v_mul_f32 v221, v221, v14
    v_mul_f32 v222, v222, v14
    v_mul_f32 v223, v223, v14
    v_mul_f32 v224, v224, v14
    v_mul_f32 v225, v225, v14
    v_mul_f32 v226, v226, v14
    v_mul_f32 v227, v227, v14
    v_mul_f32 v228, v228, v14
    v_mul_f32 v229, v229, v14
    v_mul_f32 v230, v230, v14
    v_mul_f32 v231, v231, v14
    v_mul_f32 v232, v232, v14
    v_mul_f32 v233, v233, v14
    v_mul_f32 v234, v234, v14
    v_mul_f32 v235, v235, v14
    v_mul_f32 v236, v236, v14
    v_mul_f32 v237, v237, v14
    v_mul_f32 v238, v238, v14
    v_mul_f32 v239, v239, v14
    s_waitcnt vmcnt(24)
    v_perm_b32 v16, v132, v128, s32
    v_perm_b32 v17, v140, v136, s32
    v_perm_b32 v18, v148, v144, s32
    v_perm_b32 v19, v156, v152, s32
    v_perm_b32 v20, v132, v128, s33
    v_perm_b32 v21, v140, v136, s33
    v_perm_b32 v22, v148, v144, s33
    v_perm_b32 v23, v156, v152, s33
    v_perm_b32 v24, v133, v129, s32
    v_perm_b32 v25, v141, v137, s32
    v_perm_b32 v26, v149, v145, s32
    v_perm_b32 v27, v157, v153, s32
    v_perm_b32 v28, v133, v129, s33
    v_perm_b32 v29, v141, v137, s33
    v_perm_b32 v30, v149, v145, s33
    v_perm_b32 v31, v157, v153, s33
    v_perm_b32 v32, v134, v130, s32
    v_perm_b32 v33, v142, v138, s32
    v_perm_b32 v34, v150, v146, s32
    v_perm_b32 v35, v158, v154, s32
    v_perm_b32 v36, v134, v130, s33
    v_perm_b32 v37, v142, v138, s33
    v_perm_b32 v38, v150, v146, s33
    v_perm_b32 v39, v158, v154, s33
    v_perm_b32 v40, v135, v131, s32
    v_perm_b32 v41, v143, v139, s32
    v_perm_b32 v42, v151, v147, s32
    v_perm_b32 v43, v159, v155, s32
    v_perm_b32 v44, v135, v131, s33
    v_perm_b32 v45, v143, v139, s33
    v_perm_b32 v46, v151, v147, s33
    v_perm_b32 v47, v159, v155, s33
    buffer_load_dwordx4 v[128:131], v6, s[20:23], s66 offen offset:0 nt
    buffer_load_dwordx4 v[132:135], v6, s[20:23], s66 offen offset:1024 nt
    buffer_load_dwordx4 v[136:139], v6, s[20:23], s66 offen offset:2048 nt
    buffer_load_dwordx4 v[140:143], v6, s[20:23], s66 offen offset:3072 nt
    buffer_load_dwordx4 v[144:147], v7, s[20:23], s66 offen offset:0 nt
    buffer_load_dwordx4 v[148:151], v7, s[20:23], s66 offen offset:1024 nt
    buffer_load_dwordx4 v[152:155], v7, s[20:23], s66 offen offset:2048 nt
    buffer_load_dwordx4 v[156:159], v7, s[20:23], s66 offen offset:3072 nt
    v_mfma_f32_16x16x32_bf16 v[208:211], v[16:19], v[248:251], v[208:211]
    v_mfma_f32_16x16x32_bf16 v[212:215], v[20:23], v[248:251], v[212:215]
    v_mfma_f32_16x16x32_bf16 v[216:219], v[24:27], v[248:251], v[216:219]
    v_mfma_f32_16x16x32_bf16 v[220:223], v[28:31], v[248:251], v[220:223]
    v_mfma_f32_16x16x32_bf16 v[224:227], v[32:35], v[248:251], v[224:227]
    v_mfma_f32_16x16x32_bf16 v[228:231], v[36:39], v[248:251], v[228:231]
    v_mfma_f32_16x16x32_bf16 v[232:235], v[40:43], v[248:251], v[232:235]
    v_mfma_f32_16x16x32_bf16 v[236:239], v[44:47], v[248:251], v[236:239]
    s_mov_b64 exec, 1
    ds_add_rtn_u32 v15, v56, v57
    s_mov_b64 exec, -1
    s_waitcnt vmcnt(24)
    s_nop 3
A_ck2:
    s_cmp_ge_u32 s62, s61
    s_nop 0
    s_cbranch_scc1 A_ck2e
    s_swappc_b64 s[100:101], s[98:99]
    s_nop 0
    s_branch A_ck2
A_ck2e:
    v_mfma_f32_16x16x32_bf16 v[240:243], v[96:99], v[192:195], 0
    v_mfma_f32_16x16x32_bf16 v[240:243], v[100:103], v[196:199], v[240:243]
    v_mfma_f32_16x16x32_bf16 v[240:243], v[104:107], v[200:203], v[240:243]
    v_mfma_f32_16x16x32_bf16 v[240:243], v[108:111], v[204:207], v[240:243]
    v_mfma_f32_16x16x32_bf16 v[244:247], v[112:115], v[192:195], 0
    v_mfma_f32_16x16x32_bf16 v[244:247], v[116:119], v[196:199], v[244:247]
    v_mfma_f32_16x16x32_bf16 v[244:247], v[120:123], v[200:203], v[244:247]
    v_mfma_f32_16x16x32_bf16 v[244:247], v[124:127], v[204:207], v[244:247]
    s_waitcnt lgkmcnt(0)
    v_readfirstlane_b32 s73, v15
    s_mov_b32 s61, 0
    s_add_u32 s67, s73, s28
    s_lshl_b32 s67, s67, 13
    s_lshl_b32 s63, s14, 24
    s_add_u32 s67, s67, s63
    s_cmp_ge_u32 s73, s93
    s_nop 0
    s_cbranch_scc1 A_drainB
    buffer_load_dwordx4 v[96:99], v4, s[16:19], s67 offen offset:0 nt
    buffer_load_dwordx4 v[100:103], v4, s[16:19], s67 offen offset:64 nt
    buffer_load_dwordx4 v[104:107], v4, s[16:19], s67 offen offset:128 nt
    buffer_load_dwordx4 v[108:111], v4, s[16:19], s67 offen offset:192 nt
    buffer_load_dwordx4 v[112:115], v5, s[16:19], s67 offen offset:0 nt
    buffer_load_dwordx4 v[116:119], v5, s[16:19], s67 offen offset:64 nt
    buffer_load_dwordx4 v[120:123], v5, s[16:19], s67 offen offset:128 nt
    buffer_load_dwordx4 v[124:127], v5, s[16:19], s67 offen offset:192 nt
    v_cvt_pk_bf16_f32 v10, v240, v241
    v_lshlrev_b32 v11, 16, v10
    v_and_b32 v12, 0xffff0000, v10
    v_mul_f32 v11, s35, v11
    v_mul_f32 v12, s35, v12
    v_cvt_pk_bf16_f32 v10, v11, v12
    v_lshlrev_b32 v48, 16, v10
    v_and_b32 v49, 0xffff0000, v10
    v_cvt_pk_bf16_f32 v10, v242, v243
    v_lshlrev_b32 v11, 16, v10
    v_and_b32 v12, 0xffff0000, v10
    v_mul_f32 v11, s35, v11
    v_mul_f32 v12, s35, v12
    v_cvt_pk_bf16_f32 v10, v11, v12
    v_lshlrev_b32 v50, 16, v10
    v_and_b32 v51, 0xffff0000, v10
    v_cvt_pk_bf16_f32 v10, v244, v245
    v_lshlrev_b32 v11, 16, v10
    v_and_b32 v12, 0xffff0000, v10
    v_mul_f32 v11, s35, v11
    v_mul_f32 v12, s35, v12
    v_cvt_pk_bf16_f32 v10, v11, v12
    v_lshlrev_b32 v52, 16, v10
    v_and_b32 v53, 0xffff0000, v10
    v_cvt_pk_bf16_f32 v10, v246, v247
    v_lshlrev_b32 v11, 16, v10
    v_and_b32 v12, 0xffff0000, v10
    v_mul_f32 v11, s35, v11
    v_mul_f32 v12, s35, v12
    v_cvt_pk_bf16_f32 v10, v11, v12
    v_lshlrev_b32 v54, 16, v10
    v_and_b32 v55, 0xffff0000, v10
    v_max3_f32 v10, v48, v49, v50
    v_max3_f32 v10, v10, v51, v52
    v_max3_f32 v10, v10, v53, v54
    v_max3_f32 v10, v10, v55, v8
    v_mov_b32 v11, v10
    s_nop 1
    v_permlane16_swap_b32 v10, v11
    v_max_f32 v10, v10, v11
    v_mov_b32 v11, v10
    s_nop 1
    v_permlane32_swap_b32 v10, v11
    v_max_f32 v10, v10, v11
    v_sub_f32 v14, v8, v10
    v_mul_f32 v14, s34, v14
    v_exp_f32 v14, v14
    v_mov_b32 v8, v10
    v_mul_f32 v13, s34, v10
    v_fma_f32 v48, v48, s34, -v13
    v_exp_f32 v48, v48
    v_fma_f32 v49, v49, s34, -v13
    v_exp_f32 v49, v49
    v_fma_f32 v50, v50, s34, -v13
    v_exp_f32 v50, v50
    v_fma_f32 v51, v51, s34, -v13
    v_exp_f32 v51, v51
    v_fma_f32 v52, v52, s34, -v13
    v_exp_f32 v52, v52
    v_fma_f32 v53, v53, s34, -v13
    v_exp_f32 v53, v53
    v_fma_f32 v54, v54, s34, -v13
    v_exp_f32 v54, v54
    v_fma_f32 v55, v55, s34, -v13
    v_exp_f32 v55, v55
    v_mul_f32 v9, v9, v14
    v_add_f32 v9, v9, v48
    v_add_f32 v9, v9, v49
    v_add_f32 v9, v9, v50
    v_add_f32 v9, v9, v51
    v_add_f32 v9, v9, v52
    v_add_f32 v9, v9, v53
    v_add_f32 v9, v9, v54
    v_add_f32 v9, v9, v55
    v_cvt_pk_bf16_f32 v248, v48, v49
    v_cvt_pk_bf16_f32 v249, v50, v51
    v_cvt_pk_bf16_f32 v250, v52, v53
    v_cvt_pk_bf16_f32 v251, v54, v55
    v_mul_f32 v208, v208, v14
    v_mul_f32 v209, v209, v14
    v_mul_f32 v210, v210, v14
    v_mul_f32 v211, v211, v14
    v_mul_f32 v212, v212, v14
    v_mul_f32 v213, v213, v14
    v_mul_f32 v214, v214, v14
    v_mul_f32 v215, v215, v14
    v_mul_f32 v216, v216, v14
    v_mul_f32 v217, v217, v14
    v_mul_f32 v218, v218, v14
    v_mul_f32 v219, v219, v14
    v_mul_f32 v220, v220, v14
    v_mul_f32 v221, v221, v14
    v_mul_f32 v222, v222, v14
    v_mul_f32 v223, v223, v14
    v_mul_f32 v224, v224, v14
    v_mul_f32 v225, v225, v14
    v_mul_f32 v226, v226, v14
    v_mul_f32 v227, v227, v14
    v_mul_f32 v228, v228, v14
    v_mul_f32 v229, v229, v14
    v_mul_f32 v230, v230, v14
    v_mul_f32 v231, v231, v14
    v_mul_f32 v232, v232, v14
    v_mul_f32 v233, v233, v14
    v_mul_f32 v234, v234, v14
    v_mul_f32 v235, v235, v14
    v_mul_f32 v236, v236, v14
    v_mul_f32 v237, v237, v14
    v_mul_f32 v238, v238, v14
    v_mul_f32 v239, v239, v14
    s_waitcnt vmcnt(24)
    v_perm_b32 v16, v164, v160, s32
    v_perm_b32 v17, v172, v168, s32
    v_perm_b32 v18, v180, v176, s32
    v_perm_b32 v19, v188, v184, s32
    v_perm_b32 v20, v164, v160, s33
    v_perm_b32 v21, v172, v168, s33
    v_perm_b32 v22, v180, v176, s33
    v_perm_b32 v23, v188, v184, s33
    v_perm_b32 v24, v165, v161, s32
    v_perm_b32 v25, v173, v169, s32
    v_perm_b32 v26, v181, v177, s32
    v_perm_b32 v27, v189, v185, s32
    v_perm_b32 v28, v165, v161, s33
    v_perm_b32 v29, v173, v169, s33
    v_perm_b32 v30, v181, v177, s33
    v_perm_b32 v31, v189, v185, s33
    v_perm_b32 v32, v166, v162, s32
    v_perm_b32 v33, v174, v170, s32
    v_perm_b32 v34, v182, v178, s32
    v_perm_b32 v35, v190, v186, s32
    v_perm_b32 v36, v166, v162, s33
    v_perm_b32 v37, v174, v170, s33
    v_perm_b32 v38, v182, v178, s33
    v_perm_b32 v39, v190, v186, s33
    v_perm_b32 v40, v167, v163, s32
    v_perm_b32 v41, v175, v171, s32
    v_perm_b32 v42, v183, v179, s32
    v_perm_b32 v43, v191, v187, s32
    v_perm_b32 v44, v167, v163, s33
    v_perm_b32 v45, v175, v171, s33
    v_perm_b32 v46, v183, v179, s33
    v_perm_b32 v47, v191, v187, s33
    buffer_load_dwordx4 v[160:163], v6, s[20:23], s67 offen offset:0 nt
    buffer_load_dwordx4 v[164:167], v6, s[20:23], s67 offen offset:1024 nt
    buffer_load_dwordx4 v[168:171], v6, s[20:23], s67 offen offset:2048 nt
    buffer_load_dwordx4 v[172:175], v6, s[20:23], s67 offen offset:3072 nt
    buffer_load_dwordx4 v[176:179], v7, s[20:23], s67 offen offset:0 nt
    buffer_load_dwordx4 v[180:183], v7, s[20:23], s67 offen offset:1024 nt
    buffer_load_dwordx4 v[184:187], v7, s[20:23], s67 offen offset:2048 nt
    buffer_load_dwordx4 v[188:191], v7, s[20:23], s67 offen offset:3072 nt
    v_mfma_f32_16x16x32_bf16 v[208:211], v[16:19], v[248:251], v[208:211]
    v_mfma_f32_16x16x32_bf16 v[212:215], v[20:23], v[248:251], v[212:215]
    v_mfma_f32_16x16x32_bf16 v[216:219], v[24:27], v[248:251], v[216:219]
    v_mfma_f32_16x16x32_bf16 v[220:223], v[28:31], v[248:251], v[220:223]
    v_mfma_f32_16x16x32_bf16 v[224:227], v[32:35], v[248:251], v[224:227]
    v_mfma_f32_16x16x32_bf16 v[228:231], v[36:39], v[248:251], v[228:231]
    v_mfma_f32_16x16x32_bf16 v[232:235], v[40:43], v[248:251], v[232:235]
    v_mfma_f32_16x16x32_bf16 v[236:239], v[44:47], v[248:251], v[236:239]
    s_nop 7
    s_branch A_loop
A_drainA:
    v_cvt_pk_bf16_f32 v10, v240, v241
    v_lshlrev_b32 v11, 16, v10
    v_and_b32 v12, 0xffff0000, v10
    v_mul_f32 v11, s35, v11
    v_mul_f32 v12, s35, v12
    v_cvt_pk_bf16_f32 v10, v11, v12
    v_lshlrev_b32 v48, 16, v10
    v_and_b32 v49, 0xffff0000, v10
    v_cvt_pk_bf16_f32 v10, v242, v243
    v_lshlrev_b32 v11, 16, v10
    v_and_b32 v12, 0xffff0000, v10
    v_mul_f32 v11, s35, v11
    v_mul_f32 v12, s35, v12
    v_cvt_pk_bf16_f32 v10, v11, v12
    v_lshlrev_b32 v50, 16, v10
    v_and_b32 v51, 0xffff0000, v10
    v_cvt_pk_bf16_f32 v10, v244, v245
    v_lshlrev_b32 v11, 16, v10
    v_and_b32 v12, 0xffff0000, v10
    v_mul_f32 v11, s35, v11
    v_mul_f32 v12, s35, v12
    v_cvt_pk_bf16_f32 v10, v11, v12
    v_lshlrev_b32 v52, 16, v10
    v_and_b32 v53, 0xffff0000, v10
    v_cvt_pk_bf16_f32 v10, v246, v247
    v_lshlrev_b32 v11, 16, v10
    v_and_b32 v12, 0xffff0000, v10
    v_mul_f32 v11, s35, v11
    v_mul_f32 v12, s35, v12
    v_cvt_pk_bf16_f32 v10, v11, v12
    v_lshlrev_b32 v54, 16, v10
    v_and_b32 v55, 0xffff0000, v10
    v_max3_f32 v10, v48, v49, v50
    v_max3_f32 v10, v10, v51, v52
    v_max3_f32 v10, v10, v53, v54
    v_max3_f32 v10, v10, v55, v8
    v_mov_b32 v11, v10
    s_nop 1
    v_permlane16_swap_b32 v10, v11
    v_max_f32 v10, v10, v11
    v_mov_b32 v11, v10
    s_nop 1
    v_permlane32_swap_b32 v10, v11
    v_max_f32 v10, v10, v11
    v_sub_f32 v14, v8, v10
    v_mul_f32 v14, s34, v14
    v_exp_f32 v14, v14
    v_mov_b32 v8, v10
    v_mul_f32 v13, s34, v10
    v_fma_f32 v48, v48, s34, -v13
    v_exp_f32 v48, v48
    v_fma_f32 v49, v49, s34, -v13
    v_exp_f32 v49, v49
    v_fma_f32 v50, v50, s34, -v13
    v_exp_f32 v50, v50
    v_fma_f32 v51, v51, s34, -v13
    v_exp_f32 v51, v51
    v_fma_f32 v52, v52, s34, -v13
    v_exp_f32 v52, v52
    v_fma_f32 v53, v53, s34, -v13
    v_exp_f32 v53, v53
    v_fma_f32 v54, v54, s34, -v13
    v_exp_f32 v54, v54
    v_fma_f32 v55, v55, s34, -v13
    v_exp_f32 v55, v55
    v_mul_f32 v9, v9, v14
    v_add_f32 v9, v9, v48
    v_add_f32 v9, v9, v49
    v_add_f32 v9, v9, v50
    v_add_f32 v9, v9, v51
    v_add_f32 v9, v9, v52
    v_add_f32 v9, v9, v53
    v_add_f32 v9, v9, v54
    v_add_f32 v9, v9, v55
    v_cvt_pk_bf16_f32 v248, v48, v49
    v_cvt_pk_bf16_f32 v249, v50, v51
    v_cvt_pk_bf16_f32 v250, v52, v53
    v_cvt_pk_bf16_f32 v251, v54, v55
    v_mul_f32 v208, v208, v14
    v_mul_f32 v209, v209, v14
    v_mul_f32 v210, v210, v14
    v_mul_f32 v211, v211, v14
    v_mul_f32 v212, v212, v14
    v_mul_f32 v213, v213, v14
    v_mul_f32 v214, v214, v14
    v_mul_f32 v215, v215, v14
    v_mul_f32 v216, v216, v14
    v_mul_f32 v217, v217, v14
    v_mul_f32 v218, v218, v14
    v_mul_f32 v219, v219, v14
    v_mul_f32 v220, v220, v14
    v_mul_f32 v221, v221, v14
    v_mul_f32 v222, v222, v14
    v_mul_f32 v223, v223, v14
    v_mul_f32 v224, v224, v14
    v_mul_f32 v225, v225, v14
    v_mul_f32 v226, v226, v14
    v_mul_f32 v227, v227, v14
    v_mul_f32 v228, v228, v14
    v_mul_f32 v229, v229, v14
    v_mul_f32 v230, v230, v14
    v_mul_f32 v231, v231, v14
    v_mul_f32 v232, v232, v14
    v_mul_f32 v233, v233, v14
    v_mul_f32 v234, v234, v14
    v_mul_f32 v235, v235, v14
    v_mul_f32 v236, v236, v14
    v_mul_f32 v237, v237, v14
    v_mul_f32 v238, v238, v14
    v_mul_f32 v239, v239, v14
    s_waitcnt vmcnt(16)
    v_perm_b32 v16, v132, v128, s32
    v_perm_b32 v17, v140, v136, s32
    v_perm_b32 v18, v148, v144, s32
    v_perm_b32 v19, v156, v152, s32
    v_perm_b32 v20, v132, v128, s33
    v_perm_b32 v21, v140, v136, s33
    v_perm_b32 v22, v148, v144, s33
    v_perm_b32 v23, v156, v152, s33
    v_perm_b32 v24, v133, v129, s32
    v_perm_b32 v25, v141, v137, s32
    v_perm_b32 v26, v149, v145, s32
    v_perm_b32 v27, v157, v153, s32
    v_perm_b32 v28, v133, v129, s33
    v_perm_b32 v29, v141, v137, s33
    v_perm_b32 v30, v149, v145, s33
    v_perm_b32 v31, v157, v153, s33
    v_perm_b32 v32, v134, v130, s32
    v_perm_b32 v33, v142, v138, s32
    v_perm_b32 v34, v150, v146, s32
    v_perm_b32 v35, v158, v154, s32
    v_perm_b32 v36, v134, v130, s33
    v_perm_b32 v37, v142, v138, s33
    v_perm_b32 v38, v150, v146, s33
    v_perm_b32 v39, v158, v154, s33
    v_perm_b32 v40, v135, v131, s32
    v_perm_b32 v41, v143, v139, s32
    v_perm_b32 v42, v151, v147, s32
    v_perm_b32 v43, v159, v155, s32
    v_perm_b32 v44, v135, v131, s33
    v_perm_b32 v45, v143, v139, s33
    v_perm_b32 v46, v151, v147, s33
    v_perm_b32 v47, v159, v155, s33
    v_mfma_f32_16x16x32_bf16 v[208:211], v[16:19], v[248:251], v[208:211]
    v_mfma_f32_16x16x32_bf16 v[212:215], v[20:23], v[248:251], v[212:215]
    v_mfma_f32_16x16x32_bf16 v[216:219], v[24:27], v[248:251], v[216:219]
    v_mfma_f32_16x16x32_bf16 v[220:223], v[28:31], v[248:251], v[220:223]
    v_mfma_f32_16x16x32_bf16 v[224:227], v[32:35], v[248:251], v[224:227]
    v_mfma_f32_16x16x32_bf16 v[228:231], v[36:39], v[248:251], v[228:231]
    v_mfma_f32_16x16x32_bf16 v[232:235], v[40:43], v[248:251], v[232:235]
    v_mfma_f32_16x16x32_bf16 v[236:239], v[44:47], v[248:251], v[236:239]
    s_nop 7
A_fullB:
    s_waitcnt vmcnt(0)
A_ck3:
    s_cmp_ge_u32 s62, s61
    s_nop 0
    s_cbranch_scc1 A_ck3e
    s_swappc_b64 s[100:101], s[98:99]
    s_nop 0
    s_branch A_ck3
A_ck3e:
    v_mfma_f32_16x16x32_bf16 v[240:243], v[96:99], v[192:195], 0
    v_mfma_f32_16x16x32_bf16 v[240:243], v[100:103], v[196:199], v[240:243]
    v_mfma_f32_16x16x32_bf16 v[240:243], v[104:107], v[200:203], v[240:243]
    v_mfma_f32_16x16x32_bf16 v[240:243], v[108:111], v[204:207], v[240:243]
    v_mfma_f32_16x16x32_bf16 v[244:247], v[112:115], v[192:195], 0
    v_mfma_f32_16x16x32_bf16 v[244:247], v[116:119], v[196:199], v[244:247]
    v_mfma_f32_16x16x32_bf16 v[244:247], v[120:123], v[200:203], v[244:247]
    v_mfma_f32_16x16x32_bf16 v[244:247], v[124:127], v[204:207], v[244:247]
    s_nop 3
    v_cvt_pk_bf16_f32 v10, v240, v241
    v_lshlrev_b32 v11, 16, v10
    v_and_b32 v12, 0xffff0000, v10
    v_mul_f32 v11, s35, v11
    v_mul_f32 v12, s35, v12
    v_cvt_pk_bf16_f32 v10, v11, v12
    v_lshlrev_b32 v48, 16, v10
    v_and_b32 v49, 0xffff0000, v10
    v_cvt_pk_bf16_f32 v10, v242, v243
    v_lshlrev_b32 v11, 16, v10
    v_and_b32 v12, 0xffff0000, v10
    v_mul_f32 v11, s35, v11
    v_mul_f32 v12, s35, v12
    v_cvt_pk_bf16_f32 v10, v11, v12
    v_lshlrev_b32 v50, 16, v10
    v_and_b32 v51, 0xffff0000, v10
    v_cvt_pk_bf16_f32 v10, v244, v245
    v_lshlrev_b32 v11, 16, v10
    v_and_b32 v12, 0xffff0000, v10
    v_mul_f32 v11, s35, v11
    v_mul_f32 v12, s35, v12
    v_cvt_pk_bf16_f32 v10, v11, v12
    v_lshlrev_b32 v52, 16, v10
    v_and_b32 v53, 0xffff0000, v10
    v_cvt_pk_bf16_f32 v10, v246, v247
    v_lshlrev_b32 v11, 16, v10
    v_and_b32 v12, 0xffff0000, v10
    v_mul_f32 v11, s35, v11
    v_mul_f32 v12, s35, v12
    v_cvt_pk_bf16_f32 v10, v11, v12
    v_lshlrev_b32 v54, 16, v10
    v_and_b32 v55, 0xffff0000, v10
    v_max3_f32 v10, v48, v49, v50
    v_max3_f32 v10, v10, v51, v52
    v_max3_f32 v10, v10, v53, v54
    v_max3_f32 v10, v10, v55, v8
    v_mov_b32 v11, v10
    s_nop 1
    v_permlane16_swap_b32 v10, v11
    v_max_f32 v10, v10, v11
    v_mov_b32 v11, v10
    s_nop 1
    v_permlane32_swap_b32 v10, v11
    v_max_f32 v10, v10, v11
    v_sub_f32 v14, v8, v10
    v_mul_f32 v14, s34, v14
    v_exp_f32 v14, v14
    v_mov_b32 v8, v10
    v_mul_f32 v13, s34, v10
    v_fma_f32 v48, v48, s34, -v13
    v_exp_f32 v48, v48
    v_fma_f32 v49, v49, s34, -v13
    v_exp_f32 v49, v49
    v_fma_f32 v50, v50, s34, -v13
    v_exp_f32 v50, v50
    v_fma_f32 v51, v51, s34, -v13
    v_exp_f32 v51, v51
    v_fma_f32 v52, v52, s34, -v13
    v_exp_f32 v52, v52
    v_fma_f32 v53, v53, s34, -v13
    v_exp_f32 v53, v53
    v_fma_f32 v54, v54, s34, -v13
    v_exp_f32 v54, v54
    v_fma_f32 v55, v55, s34, -v13
    v_exp_f32 v55, v55
    v_mul_f32 v9, v9, v14
    v_add_f32 v9, v9, v48
    v_add_f32 v9, v9, v49
    v_add_f32 v9, v9, v50
    v_add_f32 v9, v9, v51
    v_add_f32 v9, v9, v52
    v_add_f32 v9, v9, v53
    v_add_f32 v9, v9, v54
    v_add_f32 v9, v9, v55
    v_cvt_pk_bf16_f32 v248, v48, v49
    v_cvt_pk_bf16_f32 v249, v50, v51
    v_cvt_pk_bf16_f32 v250, v52, v53
    v_cvt_pk_bf16_f32 v251, v54, v55
    v_mul_f32 v208, v208, v14
    v_mul_f32 v209, v209, v14
    v_mul_f32 v210, v210, v14
    v_mul_f32 v211, v211, v14
    v_mul_f32 v212, v212, v14
    v_mul_f32 v213, v213, v14
    v_mul_f32 v214, v214, v14
    v_mul_f32 v215, v215, v14
    v_mul_f32 v216, v216, v14
    v_mul_f32 v217, v217, v14
    v_mul_f32 v218, v218, v14
    v_mul_f32 v219, v219, v14
    v_mul_f32 v220, v220, v14
    v_mul_f32 v221, v221, v14
    v_mul_f32 v222, v222, v14
    v_mul_f32 v223, v223, v14
    v_mul_f32 v224, v224, v14
    v_mul_f32 v225, v225, v14
    v_mul_f32 v226, v226, v14
    v_mul_f32 v227, v227, v14
    v_mul_f32 v228, v228, v14
    v_mul_f32 v229, v229, v14
    v_mul_f32 v230, v230, v14
    v_mul_f32 v231, v231, v14
    v_mul_f32 v232, v232, v14
    v_mul_f32 v233, v233, v14
    v_mul_f32 v234, v234, v14
    v_mul_f32 v235, v235, v14
    v_mul_f32 v236, v236, v14
    v_mul_f32 v237, v237, v14
    v_mul_f32 v238, v238, v14
    v_mul_f32 v239, v239, v14
    v_perm_b32 v16, v164, v160, s32
    v_perm_b32 v17, v172, v168, s32
    v_perm_b32 v18, v180, v176, s32
    v_perm_b32 v19, v188, v184, s32
    v_perm_b32 v20, v164, v160, s33
    v_perm_b32 v21, v172, v168, s33
    v_perm_b32 v22, v180, v176, s33
    v_perm_b32 v23, v188, v184, s33
    v_perm_b32 v24, v165, v161, s32
    v_perm_b32 v25, v173, v169, s32
    v_perm_b32 v26, v181, v177, s32
    v_perm_b32 v27, v189, v185, s32
    v_perm_b32 v28, v165, v161, s33
    v_perm_b32 v29, v173, v169, s33
    v_perm_b32 v30, v181, v177, s33
    v_perm_b32 v31, v189, v185, s33
    v_perm_b32 v32, v166, v162, s32
    v_perm_b32 v33, v174, v170, s32
    v_perm_b32 v34, v182, v178, s32
    v_perm_b32 v35, v190, v186, s32
    v_perm_b32 v36, v166, v162, s33
    v_perm_b32 v37, v174, v170, s33
    v_perm_b32 v38, v182, v178, s33
    v_perm_b32 v39, v190, v186, s33
    v_perm_b32 v40, v167, v163, s32
    v_perm_b32 v41, v175, v171, s32
    v_perm_b32 v42, v183, v179, s32
    v_perm_b32 v43, v191, v187, s32
    v_perm_b32 v44, v167, v163, s33
    v_perm_b32 v45, v175, v171, s33
    v_perm_b32 v46, v183, v179, s33
    v_perm_b32 v47, v191, v187, s33
    v_mfma_f32_16x16x32_bf16 v[208:211], v[16:19], v[248:251], v[208:211]
    v_mfma_f32_16x16x32_bf16 v[212:215], v[20:23], v[248:251], v[212:215]
    v_mfma_f32_16x16x32_bf16 v[216:219], v[24:27], v[248:251], v[216:219]
    v_mfma_f32_16x16x32_bf16 v[220:223], v[28:31], v[248:251], v[220:223]
    v_mfma_f32_16x16x32_bf16 v[224:227], v[32:35], v[248:251], v[224:227]
    v_mfma_f32_16x16x32_bf16 v[228:231], v[36:39], v[248:251], v[228:231]
    v_mfma_f32_16x16x32_bf16 v[232:235], v[40:43], v[248:251], v[232:235]
    v_mfma_f32_16x16x32_bf16 v[236:239], v[44:47], v[248:251], v[236:239]
    s_nop 7
    s_branch A_ldst
A_drainB:
    v_cvt_pk_bf16_f32 v10, v240, v241
    v_lshlrev_b32 v11, 16, v10
    v_and_b32 v12, 0xffff0000, v10
    v_mul_f32 v11, s35, v11
    v_mul_f32 v12, s35, v12
    v_cvt_pk_bf16_f32 v10, v11, v12
    v_lshlrev_b32 v48, 16, v10
    v_and_b32 v49, 0xffff0000, v10
    v_cvt_pk_bf16_f32 v10, v242, v243
    v_lshlrev_b32 v11, 16, v10
    v_and_b32 v12, 0xffff0000, v10
    v_mul_f32 v11, s35, v11
    v_mul_f32 v12, s35, v12
    v_cvt_pk_bf16_f32 v10, v11, v12
    v_lshlrev_b32 v50, 16, v10
    v_and_b32 v51, 0xffff0000, v10
    v_cvt_pk_bf16_f32 v10, v244, v245
    v_lshlrev_b32 v11, 16, v10
    v_and_b32 v12, 0xffff0000, v10
    v_mul_f32 v11, s35, v11
    v_mul_f32 v12, s35, v12
    v_cvt_pk_bf16_f32 v10, v11, v12
    v_lshlrev_b32 v52, 16, v10
    v_and_b32 v53, 0xffff0000, v10
    v_cvt_pk_bf16_f32 v10, v246, v247
    v_lshlrev_b32 v11, 16, v10
    v_and_b32 v12, 0xffff0000, v10
    v_mul_f32 v11, s35, v11
    v_mul_f32 v12, s35, v12
    v_cvt_pk_bf16_f32 v10, v11, v12
    v_lshlrev_b32 v54, 16, v10
    v_and_b32 v55, 0xffff0000, v10
    v_max3_f32 v10, v48, v49, v50
    v_max3_f32 v10, v10, v51, v52
    v_max3_f32 v10, v10, v53, v54
    v_max3_f32 v10, v10, v55, v8
    v_mov_b32 v11, v10
    s_nop 1
    v_permlane16_swap_b32 v10, v11
    v_max_f32 v10, v10, v11
    v_mov_b32 v11, v10
    s_nop 1
    v_permlane32_swap_b32 v10, v11
    v_max_f32 v10, v10, v11
    v_sub_f32 v14, v8, v10
    v_mul_f32 v14, s34, v14
    v_exp_f32 v14, v14
    v_mov_b32 v8, v10
    v_mul_f32 v13, s34, v10
    v_fma_f32 v48, v48, s34, -v13
    v_exp_f32 v48, v48
    v_fma_f32 v49, v49, s34, -v13
    v_exp_f32 v49, v49
    v_fma_f32 v50, v50, s34, -v13
    v_exp_f32 v50, v50
    v_fma_f32 v51, v51, s34, -v13
    v_exp_f32 v51, v51
    v_fma_f32 v52, v52, s34, -v13
    v_exp_f32 v52, v52
    v_fma_f32 v53, v53, s34, -v13
    v_exp_f32 v53, v53
    v_fma_f32 v54, v54, s34, -v13
    v_exp_f32 v54, v54
    v_fma_f32 v55, v55, s34, -v13
    v_exp_f32 v55, v55
    v_mul_f32 v9, v9, v14
    v_add_f32 v9, v9, v48
    v_add_f32 v9, v9, v49
    v_add_f32 v9, v9, v50
    v_add_f32 v9, v9, v51
    v_add_f32 v9, v9, v52
    v_add_f32 v9, v9, v53
    v_add_f32 v9, v9, v54
    v_add_f32 v9, v9, v55
    v_cvt_pk_bf16_f32 v248, v48, v49
    v_cvt_pk_bf16_f32 v249, v50, v51
    v_cvt_pk_bf16_f32 v250, v52, v53
    v_cvt_pk_bf16_f32 v251, v54, v55
    v_mul_f32 v208, v208, v14
    v_mul_f32 v209, v209, v14
    v_mul_f32 v210, v210, v14
    v_mul_f32 v211, v211, v14
    v_mul_f32 v212, v212, v14
    v_mul_f32 v213, v213, v14
    v_mul_f32 v214, v214, v14
    v_mul_f32 v215, v215, v14
    v_mul_f32 v216, v216, v14
    v_mul_f32 v217, v217, v14
    v_mul_f32 v218, v218, v14
    v_mul_f32 v219, v219, v14
    v_mul_f32 v220, v220, v14
    v_mul_f32 v221, v221, v14
    v_mul_f32 v222, v222, v14
    v_mul_f32 v223, v223, v14
    v_mul_f32 v224, v224, v14
    v_mul_f32 v225, v225, v14
    v_mul_f32 v226, v226, v14
    v_mul_f32 v227, v227, v14
    v_mul_f32 v228, v228, v14
    v_mul_f32 v229, v229, v14
    v_mul_f32 v230, v230, v14
    v_mul_f32 v231, v231, v14
    v_mul_f32 v232, v232, v14
    v_mul_f32 v233, v233, v14
    v_mul_f32 v234, v234, v14
    v_mul_f32 v235, v235, v14
    v_mul_f32 v236, v236, v14
    v_mul_f32 v237, v237, v14
    v_mul_f32 v238, v238, v14
    v_mul_f32 v239, v239, v14
    s_waitcnt vmcnt(16)
    v_perm_b32 v16, v164, v160, s32
    v_perm_b32 v17, v172, v168, s32
    v_perm_b32 v18, v180, v176, s32
    v_perm_b32 v19, v188, v184, s32
    v_perm_b32 v20, v164, v160, s33
    v_perm_b32 v21, v172, v168, s33
    v_perm_b32 v22, v180, v176, s33
    v_perm_b32 v23, v188, v184, s33
    v_perm_b32 v24, v165, v161, s32
    v_perm_b32 v25, v173, v169, s32
    v_perm_b32 v26, v181, v177, s32
    v_perm_b32 v27, v189, v185, s32
    v_perm_b32 v28, v165, v161, s33
    v_perm_b32 v29, v173, v169, s33
    v_perm_b32 v30, v181, v177, s33
    v_perm_b32 v31, v189, v185, s33
    v_perm_b32 v32, v166, v162, s32
    v_perm_b32 v33, v174, v170, s32
    v_perm_b32 v34, v182, v178, s32
    v_perm_b32 v35, v190, v186, s32
    v_perm_b32 v36, v166, v162, s33
    v_perm_b32 v37, v174, v170, s33
    v_perm_b32 v38, v182, v178, s33
    v_perm_b32 v39, v190, v186, s33
    v_perm_b32 v40, v167, v163, s32
    v_perm_b32 v41, v175, v171, s32
    v_perm_b32 v42, v183, v179, s32
    v_perm_b32 v43, v191, v187, s32
    v_perm_b32 v44, v167, v163, s33
    v_perm_b32 v45, v175, v171, s33
    v_perm_b32 v46, v183, v179, s33
    v_perm_b32 v47, v191, v187, s33
    v_mfma_f32_16x16x32_bf16 v[208:211], v[16:19], v[248:251], v[208:211]
    v_mfma_f32_16x16x32_bf16 v[212:215], v[20:23], v[248:251], v[212:215]
    v_mfma_f32_16x16x32_bf16 v[216:219], v[24:27], v[248:251], v[216:219]
    v_mfma_f32_16x16x32_bf16 v[220:223], v[28:31], v[248:251], v[220:223]
    v_mfma_f32_16x16x32_bf16 v[224:227], v[32:35], v[248:251], v[224:227]
    v_mfma_f32_16x16x32_bf16 v[228:231], v[36:39], v[248:251], v[228:231]
    v_mfma_f32_16x16x32_bf16 v[232:235], v[40:43], v[248:251], v[232:235]
    v_mfma_f32_16x16x32_bf16 v[236:239], v[44:47], v[248:251], v[236:239]
    s_nop 7
A_fullA:
    s_waitcnt vmcnt(0)
A_ck4:
    s_cmp_ge_u32 s62, s60
    s_nop 0
    s_cbranch_scc1 A_ck4e
    s_swappc_b64 s[100:101], s[98:99]
    s_nop 0
    s_branch A_ck4
A_ck4e:
    v_mfma_f32_16x16x32_bf16 v[240:243], v[64:67], v[192:195], 0
    v_mfma_f32_16x16x32_bf16 v[240:243], v[68:71], v[196:199], v[240:243]
    v_mfma_f32_16x16x32_bf16 v[240:243], v[72:75], v[200:203], v[240:243]
    v_mfma_f32_16x16x32_bf16 v[240:243], v[76:79], v[204:207], v[240:243]
    v_mfma_f32_16x16x32_bf16 v[244:247], v[80:83], v[192:195], 0
    v_mfma_f32_16x16x32_bf16 v[244:247], v[84:87], v[196:199], v[244:247]
    v_mfma_f32_16x16x32_bf16 v[244:247], v[88:91], v[200:203], v[244:247]
    v_mfma_f32_16x16x32_bf16 v[244:247], v[92:95], v[204:207], v[244:247]
    s_nop 3
    v_cvt_pk_bf16_f32 v10, v240, v241
    v_lshlrev_b32 v11, 16, v10
    v_and_b32 v12, 0xffff0000, v10
    v_mul_f32 v11, s35, v11
    v_mul_f32 v12, s35, v12
    v_cvt_pk_bf16_f32 v10, v11, v12
    v_lshlrev_b32 v48, 16, v10
    v_and_b32 v49, 0xffff0000, v10
    v_cvt_pk_bf16_f32 v10, v242, v243
    v_lshlrev_b32 v11, 16, v10
    v_and_b32 v12, 0xffff0000, v10
    v_mul_f32 v11, s35, v11
    v_mul_f32 v12, s35, v12
    v_cvt_pk_bf16_f32 v10, v11, v12
    v_lshlrev_b32 v50, 16, v10
    v_and_b32 v51, 0xffff0000, v10
    v_cvt_pk_bf16_f32 v10, v244, v245
    v_lshlrev_b32 v11, 16, v10
    v_and_b32 v12, 0xffff0000, v10
    v_mul_f32 v11, s35, v11
    v_mul_f32 v12, s35, v12
    v_cvt_pk_bf16_f32 v10, v11, v12
    v_lshlrev_b32 v52, 16, v10
    v_and_b32 v53, 0xffff0000, v10
    v_cvt_pk_bf16_f32 v10, v246, v247
    v_lshlrev_b32 v11, 16, v10
    v_and_b32 v12, 0xffff0000, v10
    v_mul_f32 v11, s35, v11
    v_mul_f32 v12, s35, v12
    v_cvt_pk_bf16_f32 v10, v11, v12
    v_lshlrev_b32 v54, 16, v10
    v_and_b32 v55, 0xffff0000, v10
    v_max3_f32 v10, v48, v49, v50
    v_max3_f32 v10, v10, v51, v52
    v_max3_f32 v10, v10, v53, v54
    v_max3_f32 v10, v10, v55, v8
    v_mov_b32 v11, v10
    s_nop 1
    v_permlane16_swap_b32 v10, v11
    v_max_f32 v10, v10, v11
    v_mov_b32 v11, v10
    s_nop 1
    v_permlane32_swap_b32 v10, v11
    v_max_f32 v10, v10, v11
    v_sub_f32 v14, v8, v10
    v_mul_f32 v14, s34, v14
    v_exp_f32 v14, v14
    v_mov_b32 v8, v10
    v_mul_f32 v13, s34, v10
    v_fma_f32 v48, v48, s34, -v13
    v_exp_f32 v48, v48
    v_fma_f32 v49, v49, s34, -v13
    v_exp_f32 v49, v49
    v_fma_f32 v50, v50, s34, -v13
    v_exp_f32 v50, v50
    v_fma_f32 v51, v51, s34, -v13
    v_exp_f32 v51, v51
    v_fma_f32 v52, v52, s34, -v13
    v_exp_f32 v52, v52
    v_fma_f32 v53, v53, s34, -v13
    v_exp_f32 v53, v53
    v_fma_f32 v54, v54, s34, -v13
    v_exp_f32 v54, v54
    v_fma_f32 v55, v55, s34, -v13
    v_exp_f32 v55, v55
    v_mul_f32 v9, v9, v14
    v_add_f32 v9, v9, v48
    v_add_f32 v9, v9, v49
    v_add_f32 v9, v9, v50
    v_add_f32 v9, v9, v51
    v_add_f32 v9, v9, v52
    v_add_f32 v9, v9, v53
    v_add_f32 v9, v9, v54
    v_add_f32 v9, v9, v55
    v_cvt_pk_bf16_f32 v248, v48, v49
    v_cvt_pk_bf16_f32 v249, v50, v51
    v_cvt_pk_bf16_f32 v250, v52, v53
    v_cvt_pk_bf16_f32 v251, v54, v55
    v_mul_f32 v208, v208, v14
    v_mul_f32 v209, v209, v14
    v_mul_f32 v210, v210, v14
    v_mul_f32 v211, v211, v14
    v_mul_f32 v212, v212, v14
    v_mul_f32 v213, v213, v14
    v_mul_f32 v214, v214, v14
    v_mul_f32 v215, v215, v14
    v_mul_f32 v216, v216, v14
    v_mul_f32 v217, v217, v14
    v_mul_f32 v218, v218, v14
    v_mul_f32 v219, v219, v14
    v_mul_f32 v220, v220, v14
    v_mul_f32 v221, v221, v14
    v_mul_f32 v222, v222, v14
    v_mul_f32 v223, v223, v14
    v_mul_f32 v224, v224, v14
    v_mul_f32 v225, v225, v14
    v_mul_f32 v226, v226, v14
    v_mul_f32 v227, v227, v14
    v_mul_f32 v228, v228, v14
    v_mul_f32 v229, v229, v14
    v_mul_f32 v230, v230, v14
    v_mul_f32 v231, v231, v14
    v_mul_f32 v232, v232, v14
    v_mul_f32 v233, v233, v14
    v_mul_f32 v234, v234, v14
    v_mul_f32 v235, v235, v14
    v_mul_f32 v236, v236, v14
    v_mul_f32 v237, v237, v14
    v_mul_f32 v238, v238, v14
    v_mul_f32 v239, v239, v14
    v_perm_b32 v16, v132, v128, s32
    v_perm_b32 v17, v140, v136, s32
    v_perm_b32 v18, v148, v144, s32
    v_perm_b32 v19, v156, v152, s32
    v_perm_b32 v20, v132, v128, s33
    v_perm_b32 v21, v140, v136, s33
    v_perm_b32 v22, v148, v144, s33
    v_perm_b32 v23, v156, v152, s33
    v_perm_b32 v24, v133, v129, s32
    v_perm_b32 v25, v141, v137, s32
    v_perm_b32 v26, v149, v145, s32
    v_perm_b32 v27, v157, v153, s32
    v_perm_b32 v28, v133, v129, s33
    v_perm_b32 v29, v141, v137, s33
    v_perm_b32 v30, v149, v145, s33
    v_perm_b32 v31, v157, v153, s33
    v_perm_b32 v32, v134, v130, s32
    v_perm_b32 v33, v142, v138, s32
    v_perm_b32 v34, v150, v146, s32
    v_perm_b32 v35, v158, v154, s32
    v_perm_b32 v36, v134, v130, s33
    v_perm_b32 v37, v142, v138, s33
    v_perm_b32 v38, v150, v146, s33
    v_perm_b32 v39, v158, v154, s33
    v_perm_b32 v40, v135, v131, s32
    v_perm_b32 v41, v143, v139, s32
    v_perm_b32 v42, v151, v147, s32
    v_perm_b32 v43, v159, v155, s32
    v_perm_b32 v44, v135, v131, s33
    v_perm_b32 v45, v143, v139, s33
    v_perm_b32 v46, v151, v147, s33
    v_perm_b32 v47, v159, v155, s33
    v_mfma_f32_16x16x32_bf16 v[208:211], v[16:19], v[248:251], v[208:211]
    v_mfma_f32_16x16x32_bf16 v[212:215], v[20:23], v[248:251], v[212:215]
    v_mfma_f32_16x16x32_bf16 v[216:219], v[24:27], v[248:251], v[216:219]
    v_mfma_f32_16x16x32_bf16 v[220:223], v[28:31], v[248:251], v[220:223]
    v_mfma_f32_16x16x32_bf16 v[224:227], v[32:35], v[248:251], v[224:227]
    v_mfma_f32_16x16x32_bf16 v[228:231], v[36:39], v[248:251], v[228:231]
    v_mfma_f32_16x16x32_bf16 v[232:235], v[40:43], v[248:251], v[232:235]
    v_mfma_f32_16x16x32_bf16 v[236:239], v[44:47], v[248:251], v[236:239]
    s_nop 7
    s_branch A_ldst
A_ldst:
    s_cmp_eq_u32 s3, 0
    s_nop 0
    s_cbranch_scc1 A_done
    s_cmp_gt_u32 s3, 0
    s_nop 0
    s_cbranch_scc1 A_done
    v_add_u32 v58, s77, v4
    v_add_u32 v59, s77, v6
    ds_read_b128 v[64:67], v58 offset:0
    ds_read_b128 v[68:71], v58 offset:64
    ds_read_b128 v[72:75], v58 offset:128
    ds_read_b128 v[76:79], v58 offset:192
    ds_read_b128 v[80:83], v58 offset:4096
    ds_read_b128 v[84:87], v58 offset:4160
    ds_read_b128 v[88:91], v58 offset:4224
    ds_read_b128 v[92:95], v58 offset:4288
    ds_read_b128 v[128:131], v59 offset:8192
    ds_read_b128 v[132:135], v59 offset:9216
    ds_read_b128 v[136:139], v59 offset:10240
    ds_read_b128 v[140:143], v59 offset:11264
    ds_read_b128 v[144:147], v59 offset:12288
    ds_read_b128 v[148:151], v59 offset:13312
    ds_read_b128 v[152:155], v59 offset:14336
    ds_read_b128 v[156:159], v59 offset:15360
A_ck5:
    s_cmp_ge_u32 s62, 0
    s_nop 0
    s_cbranch_scc1 A_ck5e
    s_swappc_b64 s[100:101], s[98:99]
    s_nop 0
    s_branch A_ck5
A_ck5e:
    s_waitcnt lgkmcnt(0)
    v_mfma_f32_16x16x32_bf16 v[240:243], v[64:67], v[192:195], 0
    v_mfma_f32_16x16x32_bf16 v[240:243], v[68:71], v[196:199], v[240:243]
    v_mfma_f32_16x16x32_bf16 v[240:243], v[72:75], v[200:203], v[240:243]
    v_mfma_f32_16x16x32_bf16 v[240:243], v[76:79], v[204:207], v[240:243]
    v_mfma_f32_16x16x32_bf16 v[244:247], v[80:83], v[192:195], 0
    v_mfma_f32_16x16x32_bf16 v[244:247], v[84:87], v[196:199], v[244:247]
    v_mfma_f32_16x16x32_bf16 v[244:247], v[88:91], v[200:203], v[244:247]
    v_mfma_f32_16x16x32_bf16 v[244:247], v[92:95], v[204:207], v[244:247]
    s_nop 3
    v_cvt_pk_bf16_f32 v10, v240, v241
    v_lshlrev_b32 v11, 16, v10
    v_and_b32 v12, 0xffff0000, v10
    v_mul_f32 v11, s35, v11
    v_mul_f32 v12, s35, v12
    v_cvt_pk_bf16_f32 v10, v11, v12
    v_lshlrev_b32 v48, 16, v10
    v_and_b32 v49, 0xffff0000, v10
    v_cvt_pk_bf16_f32 v10, v242, v243
    v_lshlrev_b32 v11, 16, v10
    v_and_b32 v12, 0xffff0000, v10
    v_mul_f32 v11, s35, v11
    v_mul_f32 v12, s35, v12
    v_cvt_pk_bf16_f32 v10, v11, v12
    v_lshlrev_b32 v50, 16, v10
    v_and_b32 v51, 0xffff0000, v10
    v_cvt_pk_bf16_f32 v10, v244, v245
    v_lshlrev_b32 v11, 16, v10
    v_and_b32 v12, 0xffff0000, v10
    v_mul_f32 v11, s35, v11
    v_mul_f32 v12, s35, v12
    v_cvt_pk_bf16_f32 v10, v11, v12
    v_lshlrev_b32 v52, 16, v10
    v_and_b32 v53, 0xffff0000, v10
    v_cvt_pk_bf16_f32 v10, v246, v247
    v_lshlrev_b32 v11, 16, v10
    v_and_b32 v12, 0xffff0000, v10
    v_mul_f32 v11, s35, v11
    v_mul_f32 v12, s35, v12
    v_cvt_pk_bf16_f32 v10, v11, v12
    v_lshlrev_b32 v54, 16, v10
    v_and_b32 v55, 0xffff0000, v10
    v_max3_f32 v10, v48, v49, v50
    v_max3_f32 v10, v10, v51, v52
    v_max3_f32 v10, v10, v53, v54
    v_max3_f32 v10, v10, v55, v8
    v_mov_b32 v11, v10
    s_nop 1
    v_permlane16_swap_b32 v10, v11
    v_max_f32 v10, v10, v11
    v_mov_b32 v11, v10
    s_nop 1
    v_permlane32_swap_b32 v10, v11
    v_max_f32 v10, v10, v11
    v_sub_f32 v14, v8, v10
    v_mul_f32 v14, s34, v14
    v_exp_f32 v14, v14
    v_mov_b32 v8, v10
    v_mul_f32 v13, s34, v10
    v_fma_f32 v48, v48, s34, -v13
    v_exp_f32 v48, v48
    v_fma_f32 v49, v49, s34, -v13
    v_exp_f32 v49, v49
    v_fma_f32 v50, v50, s34, -v13
    v_exp_f32 v50, v50
    v_fma_f32 v51, v51, s34, -v13
    v_exp_f32 v51, v51
    v_fma_f32 v52, v52, s34, -v13
    v_exp_f32 v52, v52
    v_fma_f32 v53, v53, s34, -v13
    v_exp_f32 v53, v53
    v_fma_f32 v54, v54, s34, -v13
    v_exp_f32 v54, v54
    v_fma_f32 v55, v55, s34, -v13
    v_exp_f32 v55, v55
    v_mul_f32 v9, v9, v14
    v_add_f32 v9, v9, v48
    v_add_f32 v9, v9, v49
    v_add_f32 v9, v9, v50
    v_add_f32 v9, v9, v51
    v_add_f32 v9, v9, v52
    v_add_f32 v9, v9, v53
    v_add_f32 v9, v9, v54
    v_add_f32 v9, v9, v55
    v_cvt_pk_bf16_f32 v248, v48, v49
    v_cvt_pk_bf16_f32 v249, v50, v51
    v_cvt_pk_bf16_f32 v250, v52, v53
    v_cvt_pk_bf16_f32 v251, v54, v55
    v_mul_f32 v208, v208, v14
    v_mul_f32 v209, v209, v14
    v_mul_f32 v210, v210, v14
    v_mul_f32 v211, v211, v14
    v_mul_f32 v212, v212, v14
    v_mul_f32 v213, v213, v14
    v_mul_f32 v214, v214, v14
    v_mul_f32 v215, v215, v14
    v_mul_f32 v216, v216, v14
    v_mul_f32 v217, v217, v14
    v_mul_f32 v218, v218, v14
    v_mul_f32 v219, v219, v14
    v_mul_f32 v220, v220, v14
    v_mul_f32 v221, v221, v14
    v_mul_f32 v222, v222, v14
    v_mul_f32 v223, v223, v14
    v_mul_f32 v224, v224, v14
    v_mul_f32 v225, v225, v14
    v_mul_f32 v226, v226, v14
    v_mul_f32 v227, v227, v14
    v_mul_f32 v228, v228, v14
    v_mul_f32 v229, v229, v14
    v_mul_f32 v230, v230, v14
    v_mul_f32 v231, v231, v14
    v_mul_f32 v232, v232, v14
    v_mul_f32 v233, v233, v14
    v_mul_f32 v234, v234, v14
    v_mul_f32 v235, v235, v14
    v_mul_f32 v236, v236, v14
    v_mul_f32 v237, v237, v14
    v_mul_f32 v238, v238, v14
    v_mul_f32 v239, v239, v14
    v_perm_b32 v16, v132, v128, s32
    v_perm_b32 v17, v140, v136, s32
    v_perm_b32 v18, v148, v144, s32
    v_perm_b32 v19, v156, v152, s32
    v_perm_b32 v20, v132, v128, s33
    v_perm_b32 v21, v140, v136, s33
    v_perm_b32 v22, v148, v144, s33
    v_perm_b32 v23, v156, v152, s33
    v_perm_b32 v24, v133, v129, s32
    v_perm_b32 v25, v141, v137, s32
    v_perm_b32 v26, v149, v145, s32
    v_perm_b32 v27, v157, v153, s32
    v_perm_b32 v28, v133, v129, s33
    v_perm_b32 v29, v141, v137, s33
    v_perm_b32 v30, v149, v145, s33
    v_perm_b32 v31, v157, v153, s33
    v_perm_b32 v32, v134, v130, s32
    v_perm_b32 v33, v142, v138, s32
    v_perm_b32 v34, v150, v146, s32
    v_perm_b32 v35, v158, v154, s32
    v_perm_b32 v36, v134, v130, s33
    v_perm_b32 v37, v142, v138, s33
    v_perm_b32 v38, v150, v146, s33
    v_perm_b32 v39, v158, v154, s33
    v_perm_b32 v40, v135, v131, s32
    v_perm_b32 v41, v143, v139, s32
    v_perm_b32 v42, v151, v147, s32
    v_perm_b32 v43, v159, v155, s32
    v_perm_b32 v44, v135, v131, s33
    v_perm_b32 v45, v143, v139, s33
    v_perm_b32 v46, v151, v147, s33
    v_perm_b32 v47, v159, v155, s33
    v_mfma_f32_16x16x32_bf16 v[208:211], v[16:19], v[248:251], v[208:211]
    v_mfma_f32_16x16x32_bf16 v[212:215], v[20:23], v[248:251], v[212:215]
    v_mfma_f32_16x16x32_bf16 v[216:219], v[24:27], v[248:251], v[216:219]
    v_mfma_f32_16x16x32_bf16 v[220:223], v[28:31], v[248:251], v[220:223]
    v_mfma_f32_16x16x32_bf16 v[224:227], v[32:35], v[248:251], v[224:227]
    v_mfma_f32_16x16x32_bf16 v[228:231], v[36:39], v[248:251], v[228:231]
    v_mfma_f32_16x16x32_bf16 v[232:235], v[40:43], v[248:251], v[232:235]
    v_mfma_f32_16x16x32_bf16 v[236:239], v[44:47], v[248:251], v[236:239]
    s_nop 7
A_done:
    s_lshr_b32 s84, s15, 3
    s_lshl_b32 s30, s14, 2
    s_add_u32 s84, s84, s30
    s_and_b32 s85, s15, 7
    s_mov_b32 s48, s96
    s_and_b32 s49, s97, 0xffff
    s_mov_b32 s50, 0x400000
    s_mov_b32 s51, 0x20000
    s_mov_b32 s56, s82
    s_and_b32 s57, s83, 0xffff
    s_mov_b32 s58, 0x400
    s_mov_b32 s59, 0x20000
    v_lshrrev_b32 v60, 3, v1
    s_lshl_b32 s30, s3, 4
    v_add_u32 v60, s30, v60
    v_lshlrev_b32 v61, 10, v60
    v_and_b32 v62, 7, v1
    v_lshlrev_b32 v62, 4, v62
    v_add_u32 v61, v61, v62
    v_add_u32 v62, 0x2000, v61
    s_lshl_b32 s30, s84, 17
    s_lshl_b32 s31, s85, 7
    s_add_u32 s30, s30, s31
    buffer_load_dwordx4 v[64:67], v61, s[48:51], s30 offen
    buffer_load_dwordx4 v[68:71], v62, s[48:51], s30 offen
A_ck6:
    s_cmp_ge_u32 s62, 1
    s_nop 0
    s_cbranch_scc1 A_ck6e
    s_swappc_b64 s[100:101], s[98:99]
    s_nop 0
    s_branch A_ck6
A_ck6e:
    s_waitcnt lgkmcnt(0)
    s_barrier
    v_lshrrev_b32 v16, 7, v0
    v_lshlrev_b32 v17, 2, v16
    v_lshlrev_b32 v19, 2, v0
    v_lshlrev_b32 v22, 15, v16
    v_and_b32 v23, 127, v0
    v_lshlrev_b32 v23, 3, v23
    v_add_u32 v22, v22, v23
    v_lshlrev_b32 v23, 9, v16
    ds_read_b32 v72, v17 offset:2048
    ds_read_b32 v73, v17 offset:2080
    ds_read_b32 v74, v17 offset:2112
    ds_read_b32 v75, v17 offset:2144
    ds_read_b32 v76, v17 offset:2176
    ds_read_b32 v77, v17 offset:2208
    ds_read_b32 v78, v17 offset:2240
    ds_read_b32 v79, v17 offset:2272
    ds_read_b32 v80, v17 offset:2064
    ds_read_b32 v81, v17 offset:2096
    ds_read_b32 v82, v17 offset:2128
    ds_read_b32 v83, v17 offset:2160
    ds_read_b32 v84, v17 offset:2192
    ds_read_b32 v85, v17 offset:2224
    ds_read_b32 v86, v17 offset:2256
    ds_read_b32 v87, v17 offset:2288
    ds_read_b32 v88, v19 offset:8704
    ds_read_b32 v89, v19 offset:10752
    ds_read_b32 v90, v19 offset:12800
    ds_read_b32 v91, v19 offset:14848
    ds_read_b32 v92, v19 offset:16896
    ds_read_b32 v93, v19 offset:18944
    ds_read_b32 v94, v19 offset:20992
    ds_read_b32 v95, v19 offset:23040
    s_add_u32 s30, s14, 0
    s_and_b32 s30, s30, 7
    s_mul_i32 s30, s30, 128
    s_add_u32 s30, s30, 0
    s_add_u32 s30, s30, s15
    s_lshl_b32 s31, s30, 4
    s_add_u32 s31, s31, 32768
    s_lshl_b32 s30, s30, 10
    s_add_u32 s30, s30, 1048576
    s_waitcnt lgkmcnt(0)
    v_max3_f32 v30, v72, v73, v74
    v_max3_f32 v30, v30, v75, v76
    v_max3_f32 v30, v30, v77, v78
    v_max_f32 v30, v30, v79
    v_sub_f32 v72, v72, v30
    v_mul_f32 v72, s34, v72
    v_exp_f32 v72, v72
    v_sub_f32 v73, v73, v30
    v_mul_f32 v73, s34, v73
    v_exp_f32 v73, v73
    v_sub_f32 v74, v74, v30
    v_mul_f32 v74, s34, v74
    v_exp_f32 v74, v74
    v_sub_f32 v75, v75, v30
    v_mul_f32 v75, s34, v75
    v_exp_f32 v75, v75
    v_sub_f32 v76, v76, v30
    v_mul_f32 v76, s34, v76
    v_exp_f32 v76, v76
    v_sub_f32 v77, v77, v30
    v_mul_f32 v77, s34, v77
    v_exp_f32 v77, v77
    v_sub_f32 v78, v78, v30
    v_mul_f32 v78, s34, v78
    v_exp_f32 v78, v78
    v_sub_f32 v79, v79, v30
    v_mul_f32 v79, s34, v79
    v_exp_f32 v79, v79
    v_mul_f32 v20, v72, v88
    v_mul_f32 v32, v72, v80
    v_fmac_f32 v20, v73, v89
    v_fmac_f32 v32, v73, v81
    v_fmac_f32 v20, v74, v90
    v_fmac_f32 v32, v74, v82
    v_fmac_f32 v20, v75, v91
    v_fmac_f32 v32, v75, v83
    v_fmac_f32 v20, v76, v92
    v_fmac_f32 v32, v76, v84
    v_fmac_f32 v20, v77, v93
    v_fmac_f32 v32, v77, v85
    v_fmac_f32 v20, v78, v94
    v_fmac_f32 v32, v78, v86
    v_fmac_f32 v20, v79, v95
    v_fmac_f32 v32, v79, v87
    v_mov_b32 v21, s75
    v_mov_b32 v31, s75
    v_mov_b32 v33, s75
    buffer_store_dwordx2 v[20:21], v22, s[24:27], s30 offen sc1
    v_and_b32 v24, 127, v0
    v_cmp_eq_u32 vcc, 0, v24
    s_nop 0
    s_and_saveexec_b64 s[68:69], vcc
    s_nop 2
    s_cbranch_execz A_noml0
    buffer_store_dwordx2 v[30:31], v23, s[24:27], s31 offen sc1
    buffer_store_dwordx2 v[32:33], v23, s[24:27], s31 offen offset:8 sc1
A_noml0:
    s_mov_b64 exec, s[68:69]
    s_lshl_b32 s31, s84, 9
    s_add_u32 s31, s31, 32768
    v_and_b32 v22, 31, v1
    v_lshlrev_b32 v22, 4, v22
    s_mov_b32 s72, 0
    s_cmp_lg_u32 s3, 0
    s_nop 2
    s_cbranch_scc1 A_pollo0
A_pollm:
    buffer_load_dwordx4 v[24:27], v22, s[24:27], s31 offen offset:0 sc1
    s_add_u32 s72, s72, 1
    s_waitcnt vmcnt(0)
    v_xor_b32 v20, s75, v25
    v_xor_b32 v21, s75, v27
    v_or_b32 v20, v20, v21
    v_cmp_ne_u32 vcc, 0, v20
    s_cmp_ge_u32 s72, 262144
    s_nop 3
    s_cbranch_scc1 A_pollo0
    s_cbranch_vccz A_pollo0
    s_sleep 8
    s_branch A_pollm
A_pollo0:
    s_barrier
    s_lshl_b32 s30, s84, 15
    s_add_u32 s30, s30, 1048576
    s_lshr_b32 s87, s3, 1
    s_mul_i32 s88, s87, 8192
    s_add_u32 s30, s30, s88
    v_and_b32 v20, 127, v0
    v_lshlrev_b32 v20, 3, v20
    s_nop 4
A_pollo:
    buffer_load_dwordx4 v[24:27], v22, s[24:27], s31 offen sc1
    s_mov_b32 s88, s30
    buffer_load_dwordx2 v[72:73], v20, s[24:27], s88 offen offset:0 sc1
    buffer_load_dwordx2 v[74:75], v20, s[24:27], s88 offen offset:1024 sc1
    buffer_load_dwordx2 v[76:77], v20, s[24:27], s88 offen offset:2048 sc1
    buffer_load_dwordx2 v[78:79], v20, s[24:27], s88 offen offset:3072 sc1
    s_add_u32 s88, s88, 4096
    buffer_load_dwordx2 v[80:81], v20, s[24:27], s88 offen offset:0 sc1
    buffer_load_dwordx2 v[82:83], v20, s[24:27], s88 offen offset:1024 sc1
    buffer_load_dwordx2 v[84:85], v20, s[24:27], s88 offen offset:2048 sc1
    buffer_load_dwordx2 v[86:87], v20, s[24:27], s88 offen offset:3072 sc1
    s_add_u32 s72, s72, 1
    s_waitcnt vmcnt(8)
    v_mov_b32 v40, v24
    s_nop 1
    v_max_f32_dpp v40, v40, v40 row_ror:1 row_mask:0xf bank_mask:0xf
    s_nop 1
    v_max_f32_dpp v40, v40, v40 row_ror:2 row_mask:0xf bank_mask:0xf
    s_nop 1
    v_max_f32_dpp v40, v40, v40 row_ror:4 row_mask:0xf bank_mask:0xf
    s_nop 1
    v_max_f32_dpp v40, v40, v40 row_ror:8 row_mask:0xf bank_mask:0xf
    v_mov_b32 v41, v40
    s_nop 1
    v_permlane16_swap_b32 v40, v41
    v_max_f32 v40, v40, v41
    v_mov_b32 v41, v40
    s_nop 1
    v_permlane32_swap_b32 v40, v41
    v_max_f32 v40, v40, v41
    v_sub_f32 v44, v24, v40
    v_mul_f32 v44, s34, v44
    v_exp_f32 v44, v44
    s_nop 0
    v_mul_f32 v41, v44, v26
    s_nop 1
    v_add_f32_dpp v41, v41, v41 row_ror:1 row_mask:0xf bank_mask:0xf
    s_nop 1
    v_add_f32_dpp v41, v41, v41 row_ror:2 row_mask:0xf bank_mask:0xf
    s_nop 1
    v_add_f32_dpp v41, v41, v41 row_ror:4 row_mask:0xf bank_mask:0xf
    s_nop 1
    v_add_f32_dpp v41, v41, v41 row_ror:8 row_mask:0xf bank_mask:0xf
    v_mov_b32 v42, v41
    s_nop 1
    v_permlane16_swap_b32 v41, v42
    v_add_f32 v41, v41, v42
    v_mov_b32 v42, v41
    s_nop 1
    v_permlane32_swap_b32 v41, v42
    v_add_f32 v41, v41, v42
    v_mul_f32 v41, 0.5, v41
    s_waitcnt vmcnt(0)
    v_xor_b32 v21, s75, v25
    v_xor_b32 v42, s75, v27
    v_or_b32 v21, v21, v42
    v_xor_b32 v42, s75, v73
    v_or_b32 v21, v21, v42
    v_xor_b32 v42, s75, v75
    v_or_b32 v21, v21, v42
    v_xor_b32 v42, s75, v77
    v_or_b32 v21, v21, v42
    v_xor_b32 v42, s75, v79
    v_or_b32 v21, v21, v42
    v_xor_b32 v42, s75, v81
    v_or_b32 v21, v21, v42
    v_xor_b32 v42, s75, v83
    v_or_b32 v21, v21, v42
    v_xor_b32 v42, s75, v85
    v_or_b32 v21, v21, v42
    v_xor_b32 v42, s75, v87
    v_or_b32 v21, v21, v42
    v_cmp_ne_u32 vcc, 0, v21
    s_cmp_ge_u32 s72, 262144
    s_nop 3
    s_cbranch_scc1 A_polloend
    s_cbranch_vccnz A_pollo
A_polloend:
    s_mul_i32 s87, s87, 8
    s_add_u32 s88, s87, 0
    s_and_b32 s86, s88, 63
    v_readlane_b32 s89, v44, s86
    s_nop 1
    v_mul_f32 v43, s89, v72
    s_add_u32 s88, s87, 1
    s_and_b32 s86, s88, 63
    v_readlane_b32 s89, v44, s86
    s_nop 1
    v_fmac_f32 v43, s89, v74
    s_add_u32 s88, s87, 2
    s_and_b32 s86, s88, 63
    v_readlane_b32 s89, v44, s86
    s_nop 1
    v_fmac_f32 v43, s89, v76
    s_add_u32 s88, s87, 3
    s_and_b32 s86, s88, 63
    v_readlane_b32 s89, v44, s86
    s_nop 1
    v_fmac_f32 v43, s89, v78
    s_add_u32 s88, s87, 4
    s_and_b32 s86, s88, 63
    v_readlane_b32 s89, v44, s86
    s_nop 1
    v_fmac_f32 v43, s89, v80
    s_add_u32 s88, s87, 5
    s_and_b32 s86, s88, 63
    v_readlane_b32 s89, v44, s86
    s_nop 1
    v_fmac_f32 v43, s89, v82
    s_add_u32 s88, s87, 6
    s_and_b32 s86, s88, 63
    v_readlane_b32 s89, v44, s86
    s_nop 1
    v_fmac_f32 v43, s89, v84
    s_add_u32 s88, s87, 7
    s_and_b32 s86, s88, 63
    v_readlane_b32 s89, v44, s86
    s_nop 1
    v_fmac_f32 v43, s89, v86
    v_lshlrev_b32 v20, 2, v0
    ds_write_b32 v20, v43 offset:6144
    s_waitcnt lgkmcnt(0)
    s_barrier
    v_and_b32 v20, 127, v0
    v_lshlrev_b32 v20, 2, v20
    ds_read_b32 v32, v20 offset:6144
    ds_read_b32 v33, v20 offset:6656
    ds_read_b32 v34, v20 offset:7168
    ds_read_b32 v35, v20 offset:7680
    v_rcp_f32 v36, v41
    s_waitcnt lgkmcnt(0)
    v_add_f32 v32, v32, v33
    v_add_f32 v34, v34, v35
    v_add_f32 v32, v32, v34
    v_mul_f32 v33, v32, v36
    v_fma_f32 v34, -v33, v41, v32
    v_fma_f32 v33, v34, v36, v33
    v_cvt_pk_bf16_f32 v33, v33, v33
    v_lshlrev_b32 v33, 16, v33
    ds_write_b32 v20, v33 offset:1536
    s_waitcnt lgkmcnt(0)
    s_barrier
    v_lshlrev_b32 v20, 2, v60
    ds_read_b32 v16, v20 offset:1536
    ds_read_b32 v17, v20 offset:1568
    s_waitcnt lgkmcnt(0)
    v_lshlrev_b32 v20, 16, v64
    v_and_b32 v21, 0xffff0000, v64
    v_mul_f32 v40, v20, v16
    v_mul_f32 v41, v21, v16
    v_lshlrev_b32 v20, 16, v65
    v_and_b32 v21, 0xffff0000, v65
    v_mul_f32 v42, v20, v16
    v_mul_f32 v43, v21, v16
    v_lshlrev_b32 v20, 16, v66
    v_and_b32 v21, 0xffff0000, v66
    v_mul_f32 v44, v20, v16
    v_mul_f32 v45, v21, v16
    v_lshlrev_b32 v20, 16, v67
    v_and_b32 v21, 0xffff0000, v67
    v_mul_f32 v46, v20, v16
    v_mul_f32 v47, v21, v16
    v_lshlrev_b32 v20, 16, v68
    v_and_b32 v21, 0xffff0000, v68
    v_fmac_f32 v40, v20, v17
    v_fmac_f32 v41, v21, v17
    v_lshlrev_b32 v20, 16, v69
    v_and_b32 v21, 0xffff0000, v69
    v_fmac_f32 v42, v20, v17
    v_fmac_f32 v43, v21, v17
    v_lshlrev_b32 v20, 16, v70
    v_and_b32 v21, 0xffff0000, v70
    v_fmac_f32 v44, v20, v17
    v_fmac_f32 v45, v21, v17
    v_lshlrev_b32 v20, 16, v71
    v_and_b32 v21, 0xffff0000, v71
    v_fmac_f32 v46, v20, v17
    v_fmac_f32 v47, v21, v17
    v_add_f32_dpp v40, v40, v40 row_ror:8 row_mask:0xf bank_mask:0xf
    v_add_f32_dpp v41, v41, v41 row_ror:8 row_mask:0xf bank_mask:0xf
    v_add_f32_dpp v42, v42, v42 row_ror:8 row_mask:0xf bank_mask:0xf
    v_add_f32_dpp v43, v43, v43 row_ror:8 row_mask:0xf bank_mask:0xf
    v_add_f32_dpp v44, v44, v44 row_ror:8 row_mask:0xf bank_mask:0xf
    v_add_f32_dpp v45, v45, v45 row_ror:8 row_mask:0xf bank_mask:0xf
    v_add_f32_dpp v46, v46, v46 row_ror:8 row_mask:0xf bank_mask:0xf
    v_add_f32_dpp v47, v47, v47 row_ror:8 row_mask:0xf bank_mask:0xf
    v_permlane32_swap_b32 v40, v44
    v_add_f32 v40, v40, v44
    v_permlane32_swap_b32 v41, v45
    v_add_f32 v41, v41, v45
    v_permlane32_swap_b32 v42, v46
    v_add_f32 v42, v42, v46
    v_permlane32_swap_b32 v43, v47
    v_add_f32 v43, v43, v47
    v_permlane16_swap_b32 v40, v42
    v_add_f32 v40, v40, v42
    v_permlane16_swap_b32 v41, v43
    v_add_f32 v41, v41, v43
    v_and_b32 v20, 7, v1
    v_lshlrev_b32 v20, 5, v20
    v_lshlrev_b32 v21, 3, v3
    s_lshl_b32 s30, s3, 8
    v_add3_u32 v20, v20, v21, s30
    v_cmp_gt_u32 vcc, 8, v2
    s_nop 0
    s_and_saveexec_b64 s[68:69], vcc
    ds_write_b64 v20, v[40:41] offset:4096
    s_mov_b64 exec, s[68:69]
    s_waitcnt lgkmcnt(0)
    s_barrier
    s_cmp_lg_u32 s3, 0
    s_nop 0
    s_cbranch_scc1 A_wodone
    v_lshlrev_b32 v20, 2, v1
    ds_read_b32 v40, v20 offset:4096
    ds_read_b32 v41, v20 offset:4352
    ds_read_b32 v42, v20 offset:4608
    ds_read_b32 v43, v20 offset:4864
    ds_read_b32 v44, v20 offset:5120
    ds_read_b32 v45, v20 offset:5376
    ds_read_b32 v46, v20 offset:5632
    ds_read_b32 v47, v20 offset:5888
    s_waitcnt lgkmcnt(0)
    v_add_f32 v40, v40, v41
    v_add_f32 v40, v40, v42
    v_add_f32 v40, v40, v43
    v_add_f32 v40, v40, v44
    v_add_f32 v40, v40, v45
    v_add_f32 v40, v40, v46
    v_add_f32 v40, v40, v47
    v_mov_b32 v41, s75
    v_lshlrev_b32 v20, 3, v1
    s_mul_i32 s30, s85, 46
    s_add_u32 s30, s30, s84
    s_lshl_b32 s30, s30, 9
    s_add_u32 s30, s30, 9437184
    buffer_store_dwordx2 v[40:41], v20, s[24:27], s30 offen sc1
A_wodone:
    s_cmp_lg_u32 s84, 31
    s_nop 0
    s_cbranch_scc1 A_end
    s_mul_i32 s30, s85, 46
    s_add_u32 s30, s30, s3
    s_lshl_b32 s30, s30, 9
    s_add_u32 s30, s30, 9437184
    v_lshlrev_b32 v20, 3, v1
    v_add_u32 v21, 4096, v20
    v_add_u32 v22, 8192, v20
    v_add_u32 v23, 12288, v20
    v_add_u32 v24, 16384, v20
    v_add_u32 v25, 20480, v20
    s_cmp_ge_u32 s3, 6
    s_cselect_b32 s31, 0, 1
    v_mov_b32 v26, s31
    v_cmp_eq_u32 vcc, 0, v26
    s_nop 1
    v_cndmask_b32 v25, v25, v20, vcc
    s_mov_b32 s72, 0
    s_nop 3
A_pollf:
    buffer_load_dwordx2 v[32:33], v20, s[24:27], s30 offen sc1
    buffer_load_dwordx2 v[34:35], v21, s[24:27], s30 offen sc1
    buffer_load_dwordx2 v[36:37], v22, s[24:27], s30 offen sc1
    buffer_load_dwordx2 v[38:39], v23, s[24:27], s30 offen sc1
    buffer_load_dwordx2 v[40:41], v24, s[24:27], s30 offen sc1
    buffer_load_dwordx2 v[42:43], v25, s[24:27], s30 offen sc1
    s_add_u32 s72, s72, 1
    s_waitcnt vmcnt(0)
    v_xor_b32 v28, s75, v33
    v_xor_b32 v29, s75, v35
    v_or_b32 v28, v28, v29
    v_xor_b32 v29, s75, v37
    v_or_b32 v28, v28, v29
    v_xor_b32 v29, s75, v39
    v_or_b32 v28, v28, v29
    v_xor_b32 v29, s75, v41
    v_or_b32 v28, v28, v29
    v_xor_b32 v29, s75, v43
    v_or_b32 v28, v28, v29
    v_cmp_ne_u32 vcc, 0, v28
    s_cmp_ge_u32 s72, 262144
    s_nop 3
    s_cbranch_scc1 A_pollfend
    s_cbranch_vccnz A_pollf
A_pollfend:
    v_add_f32 v32, v32, v34
    v_add_f32 v36, v36, v38
    v_add_f32 v32, v32, v36
    v_cmp_eq_u32 vcc, 0, v26
    s_nop 1
    v_cndmask_b32 v42, v42, 0, vcc
    v_add_f32 v33, v40, v42
    v_lshlrev_b32 v20, 3, v0
    ds_write_b64 v20, v[32:33] offset:8704
    s_lshl_b32 s31, s85, 7
    v_lshlrev_b32 v21, 1, v1
    buffer_load_ushort v24, v21, s[44:47], s31 offen
    s_waitcnt lgkmcnt(0)
    s_barrier
    s_cmp_lg_u32 s3, 0
    s_nop 0
    s_cbranch_scc1 A_end
    v_lshlrev_b32 v20, 3, v1
    ds_read_b64 v[32:33], v20 offset:8704
    ds_read_b64 v[34:35], v20 offset:9216
    ds_read_b64 v[36:37], v20 offset:9728
    ds_read_b64 v[38:39], v20 offset:10240
    ds_read_b64 v[40:41], v20 offset:10752
    ds_read_b64 v[42:43], v20 offset:11264
    ds_read_b64 v[44:45], v20 offset:11776
    ds_read_b64 v[46:47], v20 offset:12288
    s_waitcnt vmcnt(0) lgkmcnt(0)
    v_add_f32 v32, v32, v34
    v_add_f32 v33, v33, v35
    v_add_f32 v32, v32, v36
    v_add_f32 v33, v33, v37
    v_add_f32 v32, v32, v38
    v_add_f32 v33, v33, v39
    v_add_f32 v32, v32, v40
    v_add_f32 v33, v33, v41
    v_add_f32 v32, v32, v42
    v_add_f32 v33, v33, v43
    v_add_f32 v32, v32, v44
    v_add_f32 v33, v33, v45
    v_add_f32 v32, v32, v46
    v_add_f32 v33, v33, v47
    v_cvt_pk_bf16_f32 v32, v32, v32
    v_lshlrev_b32 v32, 16, v32
    v_cvt_pk_bf16_f32 v33, v33, v33
    v_lshlrev_b32 v33, 16, v33
    v_lshlrev_b32 v24, 16, v24
    v_add_f32 v24, v24, v32
    v_cvt_pk_bf16_f32 v24, v24, v24
    v_lshlrev_b32 v24, 16, v24
    v_add_f32 v24, v24, v33
    v_cvt_pk_bf16_f32 v24, v24, v24
    buffer_store_short v24, v21, s[56:59], s31 offen
    s_cmp_lg_u32 s85, 0
    s_nop 2
    s_cbranch_scc1 A_end
    v_mov_b32 v25, s75
    v_mov_b32 v26, 10485760
    s_mov_b64 exec, 1
    buffer_store_dword v25, v26, s[24:27], 0 offen
    s_nop 2
A_end:
    s_endpgm
A_switch:
    v_mov_b32 v11, v9
    s_nop 1
    v_permlane16_swap_b32 v9, v11
    v_add_f32 v9, v9, v11
    v_mov_b32 v11, v9
    s_nop 1
    v_permlane32_swap_b32 v9, v11
    v_add_f32 v9, v9, v11
    s_lshl_b32 s30, s62, 8
    s_lshl_b32 s31, s3, 5
    s_add_u32 s30, s30, s31
    v_lshlrev_b32 v16, 2, v2
    v_add_u32 v16, s30, v16
    v_cmp_gt_u32 vcc, 4, v1
    s_nop 0
    s_and_saveexec_b64 s[68:69], vcc
    ds_write_b32 v16, v8 offset:2048
    ds_write_b32 v16, v9 offset:2064
    s_mov_b64 exec, s[68:69]
    s_lshl_b32 s30, s62, 14
    s_lshl_b32 s31, s3, 11
    s_add_u32 s30, s30, s31
    s_add_u32 s30, s30, 8704
    v_lshlrev_b32 v19, 9, v2
    v_lshlrev_b32 v20, 7, v3
    v_add3_u32 v19, v19, v20, s30
    v_cmp_gt_u32 vcc, 4, v2
    s_nop 0
    s_and_saveexec_b64 s[68:69], vcc
    ds_write_b32 v19, v208 offset:0
    ds_write_b32 v19, v209 offset:32
    ds_write_b32 v19, v210 offset:64
    ds_write_b32 v19, v211 offset:96
    ds_write_b32 v19, v212 offset:4
    ds_write_b32 v19, v213 offset:36
    ds_write_b32 v19, v214 offset:68
    ds_write_b32 v19, v215 offset:100
    ds_write_b32 v19, v216 offset:8
    ds_write_b32 v19, v217 offset:40
    ds_write_b32 v19, v218 offset:72
    ds_write_b32 v19, v219 offset:104
    ds_write_b32 v19, v220 offset:12
    ds_write_b32 v19, v221 offset:44
    ds_write_b32 v19, v222 offset:76
    ds_write_b32 v19, v223 offset:108
    ds_write_b32 v19, v224 offset:16
    ds_write_b32 v19, v225 offset:48
    ds_write_b32 v19, v226 offset:80
    ds_write_b32 v19, v227 offset:112
    ds_write_b32 v19, v228 offset:20
    ds_write_b32 v19, v229 offset:52
    ds_write_b32 v19, v230 offset:84
    ds_write_b32 v19, v231 offset:116
    ds_write_b32 v19, v232 offset:24
    ds_write_b32 v19, v233 offset:56
    ds_write_b32 v19, v234 offset:88
    ds_write_b32 v19, v235 offset:120
    ds_write_b32 v19, v236 offset:28
    ds_write_b32 v19, v237 offset:60
    ds_write_b32 v19, v238 offset:92
    ds_write_b32 v19, v239 offset:124
    s_mov_b64 exec, s[68:69]
    s_add_u32 s62, s62, 1
    s_cmp_ge_u32 s62, 1
    s_nop 0
    s_cbranch_scc1 A_swret
    v_and_b32 v10, 3, v2
    v_lshlrev_b32 v10, 8, v10
    v_lshlrev_b32 v11, 4, v3
    v_add_u32 v10, v10, v11
    s_lshl_b32 s30, s62, 10
    s_add_u32 s30, s30, 25088
    v_add_u32 v10, s30, v10
    ds_read_b128 v[192:195], v10 offset:0
    ds_read_b128 v[196:199], v10 offset:64
    ds_read_b128 v[200:203], v10 offset:128
    ds_read_b128 v[204:207], v10 offset:192
    v_mov_b32 v8, 0xff800000
    v_mov_b32 v9, 0
    v_mov_b32 v208, 0
    v_mov_b32 v209, 0
    v_mov_b32 v210, 0
    v_mov_b32 v211, 0
    v_mov_b32 v212, 0
    v_mov_b32 v213, 0
    v_mov_b32 v214, 0
    v_mov_b32 v215, 0
    v_mov_b32 v216, 0
    v_mov_b32 v217, 0
    v_mov_b32 v218, 0
    v_mov_b32 v219, 0
    v_mov_b32 v220, 0
    v_mov_b32 v221, 0
    v_mov_b32 v222, 0
    v_mov_b32 v223, 0
    v_mov_b32 v224, 0
    v_mov_b32 v225, 0
    v_mov_b32 v226, 0
    v_mov_b32 v227, 0
    v_mov_b32 v228, 0
    v_mov_b32 v229, 0
    v_mov_b32 v230, 0
    v_mov_b32 v231, 0
    v_mov_b32 v232, 0
    v_mov_b32 v233, 0
    v_mov_b32 v234, 0
    v_mov_b32 v235, 0
    v_mov_b32 v236, 0
    v_mov_b32 v237, 0
    v_mov_b32 v238, 0
    v_mov_b32 v239, 0
    v_cmp_gt_u32 vcc, 4, v2
    s_waitcnt lgkmcnt(0)
    s_nop 0
    v_cndmask_b32 v192, 0, v192, vcc
    v_cndmask_b32 v193, 0, v193, vcc
    v_cndmask_b32 v194, 0, v194, vcc
    v_cndmask_b32 v195, 0, v195, vcc
    v_cndmask_b32 v196, 0, v196, vcc
    v_cndmask_b32 v197, 0, v197, vcc
    v_cndmask_b32 v198, 0, v198, vcc
    v_cndmask_b32 v199, 0, v199, vcc
    v_cndmask_b32 v200, 0, v200, vcc
    v_cndmask_b32 v201, 0, v201, vcc
    v_cndmask_b32 v202, 0, v202, vcc
    v_cndmask_b32 v203, 0, v203, vcc
    v_cndmask_b32 v204, 0, v204, vcc
    v_cndmask_b32 v205, 0, v205, vcc
    v_cndmask_b32 v206, 0, v206, vcc
    v_cndmask_b32 v207, 0, v207, vcc
    s_nop 4
A_swret:
    s_setpc_b64 s[100:101]
A_codeend:
.section .rodata,"a"
.p2align 6
.amdhsa_kernel parallel_sum__gqa_block_cached__glu_gated_swiglu__decode_kernel
  .amdhsa_next_free_vgpr 252
  .amdhsa_next_free_sgpr 102
  .amdhsa_accum_offset 252
  .amdhsa_group_segment_fixed_size 0
  .amdhsa_kernarg_size 96
  .amdhsa_user_sgpr_count 2
  .amdhsa_user_sgpr_kernarg_segment_ptr 1
  .amdhsa_system_sgpr_workgroup_id_x 1
.end_amdhsa_kernel
.text
```
